```python
import torch

def _softmax(x, axis=-1):
    return torch.softmax(x, dim=axis)

def _gelu(x):
    return torch.nn.functional.gelu(x, approximate='tanh')

def _silu(x):
    return torch.nn.functional.silu(x)

def _sigmoid(x):
    return torch.sigmoid(x)

def _layernorm(x, axis=-1, eps=1e-05):
    m = x.mean(dim=axis, keepdim=True)
    v = x.var(dim=axis, keepdim=True, unbiased=False)
    return (x - m) / torch.sqrt(v + eps)

def _scatter_add(tgt, idx, src, axis=0):
    return tgt.clone().index_add_(axis, idx, src)

def _segment_sum(src, seg, n):
    out = torch.zeros((n,) + src.shape[1:], dtype=src.dtype)
    return out.index_add_(0, seg, src)

def _pad(x, pw):
    flat = tuple((v for pair in reversed(pw) for v in pair))
    return torch.nn.functional.pad(x, flat)
kernel_name = 'adaLN_cond__sliding_block_cached__dense_activation_silu__decode'

def setup_inputs():

    _w = lambda a: (lambda t: t.to(torch.bfloat16) if t.is_floating_point() else t)(torch.as_tensor(a))

    def _A_setup():
        B, Sq, D = (1, 1, 448)
        Hq, Hkv, Sk, Dh = (16, 8, 65536, 256)
        assert Hq % Hkv == 0, (Hq, Hkv)
        return {'x': _w((lambda *s: torch.randn(*s, dtype=torch.bfloat16) * 0.1)(B, Sq, D)), 'k_cache': _w((lambda *s: torch.randn(*s, dtype=torch.bfloat16) * 0.8)(B, Hkv, Sk, Dh)), 'v_cache': _w((lambda *s: torch.randn(*s, dtype=torch.bfloat16) * 3.2)(B, Hkv, Sk, Dh)), 'wq': _w((lambda *s: torch.randn(*s, dtype=torch.bfloat16) * 0.8)(D, Hq * Dh) * D ** (-0.5)), 'wo': _w((lambda *s: torch.randn(*s, dtype=torch.bfloat16) * 3.2)(Hq * Dh, D) * (Hq * Dh) ** (-0.5))}
    _A_in = _A_setup()

    def _B_setup():
        B, S, D, F = (1, 1, 448, 1792)
        return {'x': _w((lambda *s: torch.randn(*s, dtype=torch.bfloat16) * 0.1)(B, S, D)), 'w1': _w((lambda *s: torch.randn(*s, dtype=torch.bfloat16) * 3.2)(D, F) * D ** (-0.5)), 'w2': _w((lambda *s: torch.randn(*s, dtype=torch.bfloat16) * 3.2)(F, D) * F ** (-0.5))}
    _B_in = _B_setup()
    return {'A_x': _A_in['x'], 'A_k_cache': _A_in['k_cache'], 'A_v_cache': _A_in['v_cache'], 'A_wq': _A_in['wq'], 'A_wo': _A_in['wo'], 'B_x': _B_in['x'], 'B_w1': _B_in['w1'], 'B_w2': _B_in['w2'], 'c': _w((lambda *s: torch.randn(*s, dtype=torch.bfloat16) * 0.4)(1, 448) * 8.0), 'w_mod': _w((lambda *s: torch.randn(*s, dtype=torch.bfloat16) * 0.4)(448, 6 * 448) * 448 ** (-0.5) * 8.0)}

def reference(A_x, A_k_cache, A_v_cache, A_wq, A_wo, B_x, B_w1, B_w2, c, w_mod):

    def _A_ref(x, k_cache, v_cache, wq, wo):
        B, Sq, D = x.shape
        Hq, Dh = (16, 256)
        Hkv, Sk = (k_cache.shape[1], k_cache.shape[2])
        W = min(4096, max(256, Sk // 4))
        rep = Hq // Hkv
        q = (lambda x, *d: x.permute(*d))((x @ wq).reshape(B, Sq, Hq, Dh), 0, 2, 1, 3)
        k = (lambda x, n, axis: torch.repeat_interleave(x, n, dim=axis))(k_cache[:, :, Sk - W:, :], rep, axis=1)
        v = (lambda x, n, axis: torch.repeat_interleave(x, n, dim=axis))(v_cache[:, :, Sk - W:, :], rep, axis=1)
        scores = torch.einsum('bhqd,bhkd->bhqk', q, k) * Dh ** (-0.5)
        p = _softmax(scores, axis=-1)
        o = torch.einsum('bhqk,bhkd->bhqd', p, v)
        return (lambda x, *d: x.permute(*d))(o, 0, 2, 1, 3).reshape(B, Sq, Hq * Dh) @ wo

    def _B_ref(x, w1, w2):
        h = torch.einsum('bsd,df->bsf', x, w1)
        h = _silu(h)
        out = torch.einsum('bsf,fd->bsd', h, w2)
        return out
    x = A_x
    mod = (_silu(c) @ w_mod).reshape(c.shape[0], 6, 1, -1)
    sa, ca, ga, sb, cb, gb = (mod[:, 0].clone(), mod[:, 1].clone(), mod[:, 2].clone(), mod[:, 3].clone(), mod[:, 4].clone(), mod[:, 5].clone())
    h = _layernorm(x, axis=-1) * (1 + ca) + sa
    x = x + ga * _A_ref(h, A_k_cache, A_v_cache, A_wq, A_wo)
    h = _layernorm(x, axis=-1) * (1 + cb) + sb
    x = x + gb * _B_ref(h, B_w1, B_w2)
    return x
```

```asm
; @launch grid=(256,1,1) block=(1024,1,1) lds=24832
.amdgcn_target "amdgcn-amd-amdhsa--gfx950"
.text
.globl adaLN_cond__sliding_block_cached__dense_activation_silu__decode_kernel
.p2align 12
.p2align 8
.type adaLN_cond__sliding_block_cached__dense_activation_silu__decode_kernel,@function
adaLN_cond__sliding_block_cached__dense_activation_silu__decode_kernel:
    s_load_dwordx16 s[4:19], s[0:1], 0
    s_load_dwordx8 s[20:27], s[0:1], 64
    s_load_dwordx2 s[28:29], s[0:1], 96
    v_readfirstlane_b32 s31, v0
    s_and_b32 s32, s2, 7
    s_lshr_b32 s33, s2, 3
    s_lshr_b32 s31, s31, 6
    s_sub_u32 s33, s33, 8
    s_cbranch_scc0 L_A
    s_getpc_b64 s[48:49]
L_pc:
    v_lshlrev_b32 v2, 7, v0
    v_min_u32 v2, L_code_end-L_pc-4, v2
    global_load_dword v127, v2, s[48:49]
    s_branch L_F
L_A:
    s_cmp_ge_u32 s31, 8
    s_cbranch_scc1 L_Td
    s_cmp_ge_u32 s33, 17
    s_cbranch_scc1 L_a_u
L_att:
    s_mul_i32 s50, s33, 4
    s_add_u32 s51, s50, 6
    s_min_u32 s50, s50, 13
    s_min_u32 s51, s51, 15
    s_mul_i32 s49, s33, 43
L_att2:
    s_add_u32 s50, s50, s31
    s_min_u32 s48, s50, s51
    s_add_u32 s48, s48, s49
    s_mul_i32 s49, s31, 5
    s_add_u32 s48, s48, s49
    s_lshl_b32 s49, s32, 14
    s_add_u32 s48, s48, s49
    s_addk_i32 s48, 15362
    s_lshl_b32 s48, s48, 11
    v_and_b32 v2, 12, v0
    v_and_b32 v3, 48, v0
    v_and_b32 v4, 3, v0
    v_lshlrev_b32 v6, 7, v2
    v_lshl_add_u32 v6, v3, 2, v6
    v_lshl_add_u32 v6, v4, 4, v6
    s_waitcnt lgkmcnt(0)
    s_add_u32 s36, s6, s48
    s_addc_u32 s37, s7, 0
    s_cmp_le_u32 s50, s51
    s_cbranch_scc0 L_a_k1
    global_load_dwordx4 v[8:11], v6, s[36:37] offset:-4096 nt
    global_load_dwordx4 v[12:15], v6, s[36:37] offset:-3840 nt
L_a_k1:
    global_load_dwordx4 v[16:19], v6, s[36:37] offset:-2048 nt
    global_load_dwordx4 v[20:23], v6, s[36:37] offset:-1792 nt
    s_branch L_a_c
L_a_u:
    s_cmp_ge_u32 s33, 24
    s_cbranch_scc1 L_end
    s_barrier
    s_mov_b32 s50, 64
    s_mov_b32 s51, 63
    s_mul_i32 s49, s33, 40
    s_branch L_att2
L_Td:
    s_cmp_ge_u32 s33, 24
    s_cbranch_scc1 L_end
    s_sub_u32 s50, s33, 0
    s_cmp_ge_u32 s50, 3
    s_cselect_b32 s50, 9, 0
    s_cmp_eq_u32 s31, s50
    s_cbranch_scc1 L_mod
    s_cmp_ge_u32 s31, 12
    s_cbranch_scc0 L_T0
    v_mov_b32 v8, 0xff61b1e6
    v_cmp_eq_u32 vcc, 896, v0
    v_lshlrev_b32 v2, 4, v0
    v_mov_b32 v9, 0
    v_cndmask_b32 v8, 0, v8, vcc
    v_mov_b32 v11, 0
    v_subrev_u32 v2, 12288, v2
    v_mov_b32 v10, v8
    ds_write_b128 v2, v[8:11]
    s_waitcnt lgkmcnt(0)
L_T0:
    s_barrier
    s_branch L_T
L_mod:
    v_and_b32 v0, 63, v0
    s_setprio 3
    s_cmp_ge_u32 s33, 17
    s_cselect_b32 s50, -17, 4
    s_add_u32 s50, s50, s33
    s_lshl_b32 s50, s50, 3
    s_add_u32 s50, s50, s32
    s_and_b32 s51, s50, 3
    s_lshr_b32 s52, s50, 2
    s_mov_b32 s38, 2408448
    s_mov_b32 s39, 0x20000
    s_movk_i32 s42, 896
    s_mov_b32 s43, 0x20000
    s_mul_i32 s54, s51, 602112
    s_lshl_b32 s55, s52, 7
    s_add_u32 s54, s54, s55
    s_mul_i32 s53, s51, 224
    v_lshlrev_b32 v2, 2, v0
    v_lshrrev_b32 v1, 3, v0
    v_mul_u32_u24 v3, 75264, v1
    v_and_b32 v4, 7, v0
    v_lshl_add_u32 v3, v4, 4, v3
    s_waitcnt lgkmcnt(0)
    s_mov_b64 s[36:37], s[22:23]
    s_mov_b64 s[40:41], s[20:21]
    buffer_load_dword v8, v2, s[40:43], s53 offen
    buffer_load_dwordx4 v[72:75], v3, s[36:39], s54 offen nt
    s_addk_i32 s54, 5376
    buffer_load_dwordx4 v[76:79], v3, s[36:39], s54 offen nt
    s_addk_i32 s54, 5376
    buffer_load_dwordx4 v[80:83], v3, s[36:39], s54 offen nt
    s_addk_i32 s54, 5376
    buffer_load_dwordx4 v[84:87], v3, s[36:39], s54 offen nt
    s_addk_i32 s54, 5376
    buffer_load_dwordx4 v[88:91], v3, s[36:39], s54 offen nt
    s_addk_i32 s54, 5376
    buffer_load_dwordx4 v[92:95], v3, s[36:39], s54 offen nt
    s_addk_i32 s54, 5376
    buffer_load_dwordx4 v[96:99], v3, s[36:39], s54 offen nt
    s_addk_i32 s54, 5376
    buffer_load_dwordx4 v[100:103], v3, s[36:39], s54 offen nt
    s_addk_i32 s54, 5376
    buffer_load_dwordx4 v[104:107], v3, s[36:39], s54 offen nt
    s_addk_i32 s54, 5376
    buffer_load_dwordx4 v[108:111], v3, s[36:39], s54 offen nt
    s_addk_i32 s54, 5376
    buffer_load_dwordx4 v[112:115], v3, s[36:39], s54 offen nt
    s_addk_i32 s54, 5376
    buffer_load_dwordx4 v[116:119], v3, s[36:39], s54 offen nt
    s_addk_i32 s54, 5376
    buffer_load_dwordx4 v[120:123], v3, s[36:39], s54 offen nt
    s_addk_i32 s54, 5376
    buffer_load_dwordx4 v[124:127], v3, s[36:39], s54 offen nt
    s_barrier
    s_branch L_mod2
L_F:
    s_add_u32 s33, s33, 8
    v_and_b32 v0, 63, v0
    s_cmp_ge_u32 s31, 7
    s_cbranch_scc1 L_F7s
    s_lshl_b32 s48, s31, 19
    s_lshl_b32 s49, s32, 10
    s_add_u32 s48, s48, s49
    s_lshl_b32 s49, s33, 7
    s_add_u32 s48, s48, s49
    v_lshrrev_b32 v3, 4, v0
    v_lshlrev_b32 v2, 16, v3
    v_and_b32 v4, 8, v0
    v_lshl_add_u32 v2, v4, 10, v2
    v_and_b32 v5, 7, v0
    v_lshl_add_u32 v2, v5, 4, v2
    v_lshl_add_u32 v5, v5, 4, v4
    v_lshl_add_u32 v6, v3, 1, v5
    s_lshl_b32 s50, s31, 7
    v_add_u32 v101, s50, v6
    v_lshlrev_b32 v7, 4, v0
    s_mov_b32 s38, 3670016
    s_mov_b32 s39, 0x20000
    s_movk_i32 s42, 896
    s_mov_b32 s43, 0x20000
    s_waitcnt lgkmcnt(0)
    s_mov_b64 s[36:37], s[10:11]
    s_mov_b64 s[40:41], s[4:5]
    buffer_load_dwordx4 v[96:99], v7, s[40:43], 0 offen
    buffer_load_ushort v100, v101, s[40:43], 0 offen
    buffer_load_dwordx4 v[32:35], v2, s[36:39], s48 offen nt
    s_addk_i32 s48, 16384
    buffer_load_dwordx4 v[36:39], v2, s[36:39], s48 offen nt
    s_addk_i32 s48, 16384
    buffer_load_dwordx4 v[40:43], v2, s[36:39], s48 offen nt
    s_addk_i32 s48, 16384
    buffer_load_dwordx4 v[44:47], v2, s[36:39], s48 offen nt
    s_add_u32 s48, s48, 212992
    s_barrier
    buffer_load_dwordx4 v[48:51], v2, s[36:39], s48 offen nt
    s_addk_i32 s48, 16384
    buffer_load_dwordx4 v[52:55], v2, s[36:39], s48 offen nt
    s_addk_i32 s48, 16384
    buffer_load_dwordx4 v[56:59], v2, s[36:39], s48 offen nt
    s_addk_i32 s48, 16384
    buffer_load_dwordx4 v[60:63], v2, s[36:39], s48 offen nt
    s_branch L_F2
L_F7s:
    s_cmp_ge_u32 s31, 9
    s_cbranch_scc1 L_F9
    v_mov_b32 v2, 0
    v_lshlrev_b32 v3, 2, v0
    ds_write_b32 v3, v2 offset:512
    s_waitcnt lgkmcnt(0)
    s_barrier
    s_branch L_F7
L_F9:
    s_endpgm
L_a_c:
    s_load_dword s30, s[28:29], 0
    s_cmp_le_u32 s50, s51
    s_cselect_b32 s51, 1, 0
    s_add_u32 s40, s8, s48
    s_addc_u32 s41, s9, 0
    s_add_u32 s38, s36, 8192
    s_addc_u32 s39, s37, 0
    s_add_u32 s42, s40, 8192
    s_addc_u32 s43, s41, 0
    s_cmp_ge_u32 s33, 17
    s_cbranch_scc1 L_a_nb2
    s_barrier
L_a_nb2:
    v_and_b32 v0, 63, v0
    v_and_b32 v5, 15, v0
    v_lshlrev_b32 v7, 5, v3
    v_lshl_add_u32 v7, v5, 4, v7
    v_bfe_u32 v2, v0, 3, 1
    v_lshlrev_b32 v1, 10, v2
    v_lshl_add_u32 v1, v3, 3, v1
    v_lshl_add_u32 v1, v4, 5, v1
    v_and_b32 v104, 1, v0
    v_lshlrev_b32 v104, 4, v104
    v_mov_b32 v105, 0xffff
    v_lshlrev_b32 v104, v104, v105
    v_bfe_u32 v105, v0, 1, 2
    v_cmp_eq_u32 vcc, 0, v105
    s_nop 1
    v_cndmask_b32 v2, 0, v104, vcc
    v_cmp_eq_u32 vcc, 1, v105
    s_nop 1
    v_cndmask_b32 v3, 0, v104, vcc
    v_cmp_eq_u32 vcc, 2, v105
    s_nop 1
    v_cndmask_b32 v4, 0, v104, vcc
    v_cmp_eq_u32 vcc, 3, v105
    s_nop 1
    v_cndmask_b32 v5, 0, v104, vcc
    s_mov_b32 s44, s28
    s_mov_b32 s45, s29
    s_mov_b32 s46, 1441792
    s_mov_b32 s47, 0x20000
    s_mov_b32 s60, 0x05040100
    s_mov_b32 s61, 0x07060302
    s_mov_b32 s58, 0x3db8aa3b
    s_bfe_u32 s57, s31, 0x10001
    s_lshl_b32 s49, s32, 1
    s_add_u32 s54, s57, s49
    s_mul_i32 s54, s54, 24
    s_add_u32 s54, s54, s33
    s_lshl_b32 s54, s54, 10
    s_lshr_b32 s49, s31, 2
    s_lshl_b32 s49, s49, 9
    s_add_u32 s54, s54, s49
    s_and_b32 s49, s31, 1
    s_lshl_b32 s49, s49, 8
    s_add_u32 s54, s54, s49
    s_add_u32 s55, s54, 1048576
    s_add_u32 s54, s54, 655360
    s_mul_i32 s59, s32, 24
    s_add_u32 s59, s59, s33
    s_lshl_b32 s59, s59, 7
    s_add_u32 s59, s59, 49152
    v_lshlrev_b32 v104, 2, v0
    s_mov_b32 s48, s51
    s_mov_b32 s49, 0
    s_mov_b64 vcc, s[48:49]
    s_waitcnt vmcnt(3)
    s_cbranch_vccnz L_w4_
    s_waitcnt vmcnt(2)
L_w4_:
    global_load_dwordx4 v[24:27], v6, s[36:37] offset:0 nt
    s_waitcnt vmcnt(3)
    s_cbranch_vccnz L_w5_
    s_waitcnt vmcnt(2)
L_w5_:
    global_load_dwordx4 v[28:31], v6, s[36:37] offset:256 nt
    s_waitcnt vmcnt(3)
    s_cbranch_vccnz L_w6_
    s_waitcnt vmcnt(2)
L_w6_:
    global_load_dwordx4 v[32:35], v6, s[36:37] offset:2048 nt
    s_waitcnt vmcnt(3)
    s_cbranch_vccnz L_w7_
    s_waitcnt vmcnt(2)
L_w7_:
    global_load_dwordx4 v[36:39], v6, s[36:37] offset:2304 nt
    s_waitcnt lgkmcnt(0)
    s_add_u32 s30, s30, 1
    s_and_b32 s34, s30, 0x7f
    s_xor_b32 s35, s34, 0x5a
    s_lshl_b32 s3, s35, 8
    s_or_b32 s3, s3, s34
    s_waitcnt vmcnt(3)
    s_cbranch_vccnz L_w8_
    s_waitcnt vmcnt(2)
L_w8_:
    global_load_dwordx4 v[40:43], v6, s[38:39] offset:-4096 nt
    s_waitcnt vmcnt(3)
    s_cbranch_vccnz L_w9_
    s_waitcnt vmcnt(2)
L_w9_:
    global_load_dwordx4 v[44:47], v6, s[38:39] offset:-3840 nt
    s_waitcnt vmcnt(3)
    s_cbranch_vccnz L_w10_
    s_waitcnt vmcnt(2)
L_w10_:
    global_load_dwordx4 v[48:51], v6, s[38:39] offset:-2048 nt
    s_waitcnt vmcnt(3)
    s_cbranch_vccnz L_w11_
    s_waitcnt vmcnt(2)
L_w11_:
    global_load_dwordx4 v[52:55], v6, s[38:39] offset:-1792 nt
    s_cmp_eq_u32 s51, 0
    s_cbranch_scc0 L_a_v0
    v_mov_b32 v8, 0xf149f2ca
    v_mov_b32 v9, 0xf149f2ca
    v_mov_b32 v10, 0xf149f2ca
    v_mov_b32 v11, 0xf149f2ca
    s_branch L_a_v1
L_a_v0:
    s_waitcnt vmcnt(5)
    s_cbranch_vccnz L_w12_
    s_waitcnt vmcnt(4)
L_w12_:
    global_load_dwordx4 v[56:59], v7, s[40:41] offset:-4096 nt
    s_waitcnt vmcnt(5)
    s_cbranch_vccnz L_w13_
    s_waitcnt vmcnt(4)
L_w13_:
    global_load_dwordx4 v[60:63], v7, s[40:41] offset:-3840 nt
L_a_v1:
    s_waitcnt vmcnt(5)
    s_cbranch_vccnz L_w14_
    s_waitcnt vmcnt(4)
L_w14_:
    global_load_dwordx4 v[64:67], v7, s[40:41] offset:-2048 nt
    s_waitcnt vmcnt(5)
    s_cbranch_vccnz L_w15_
    s_waitcnt vmcnt(4)
L_w15_:
    global_load_dwordx4 v[68:71], v7, s[40:41] offset:-1792 nt
    buffer_load_dword v6, v104, s[44:47], s55 offen sc1
    s_waitcnt vmcnt(5)
    s_cbranch_vccnz L_w16_
    s_waitcnt vmcnt(4)
L_w16_:
    global_load_dwordx4 v[72:75], v7, s[40:41] offset:0 nt
    s_waitcnt vmcnt(5)
    s_cbranch_vccnz L_w17_
    s_waitcnt vmcnt(4)
L_w17_:
    global_load_dwordx4 v[76:79], v7, s[40:41] offset:256 nt
    s_waitcnt vmcnt(6)
    global_load_dwordx4 v[80:83], v7, s[40:41] offset:2048 nt
    s_waitcnt vmcnt(6)
    global_load_dwordx4 v[84:87], v7, s[40:41] offset:2304 nt
L_a_pd:
    s_mov_b32 s62, 0
    s_mov_b32 s63, 0
    s_branch L_a_q0
L_mod2:
    s_load_dword s30, s[28:29], 0
    s_sub_u32 s49, s31, 8
    s_mov_b32 s44, s28
    s_mov_b32 s45, s29
    s_mov_b32 s46, 1441792
    s_mov_b32 s47, 0x20000
    s_mov_b32 s60, 0x05040100
    s_mov_b32 s61, 0x07060302
    s_lshl_b32 s56, s49, 8
    s_add_u32 s56, s56, 20480
    v_mul_u32_u24 v3, 37, v0
    v_lshrrev_b32 v3, 8, v3
    v_add_u32 v3, v3, v0
    v_lshl_add_u32 v3, v3, 2, s56
    v_lshl_add_u32 v1, v1, 5, s56
    v_and_b32 v9, 1, v0
    v_lshlrev_b32 v9, 4, v9
    v_mov_b32 v10, 0xffff
    v_lshlrev_b32 v9, v9, v10
    v_bfe_u32 v10, v0, 1, 2
    v_cmp_eq_u32 vcc, 0, v10
    s_nop 1
    v_cndmask_b32 v4, 0, v9, vcc
    v_cmp_eq_u32 vcc, 1, v10
    s_nop 1
    v_cndmask_b32 v5, 0, v9, vcc
    v_cmp_eq_u32 vcc, 2, v10
    s_nop 1
    v_cndmask_b32 v6, 0, v9, vcc
    v_cmp_eq_u32 vcc, 3, v10
    s_nop 1
    v_cndmask_b32 v7, 0, v9, vcc
    s_mov_b32 s52, 0x01000100
    s_mov_b32 s53, 0x03020302
    s_waitcnt vmcnt(14)
    v_lshlrev_b32 v9, 16, v8
    v_and_b32 v10, 0xffff0000, v8
    s_mov_b32 s58, 0xbfb8aa3b
    v_mul_f32 v12, s58, v9
    v_fma_f32 v13, v9, s58, -v12
    v_fmac_f32 v13, 0xb2a57060, v9
    v_min_f32 v12, 0x42fc0000, v12
    v_exp_f32 v12, v12
    v_mul_f32 v13, 0x3f317218, v13
    v_fmac_f32 v12, v12, v13
    v_add_f32 v12, 1.0, v12
    v_rcp_f32 v13, v12
    s_nop 0
    v_mul_f32 v14, v9, v13
    v_fma_f32 v12, -v14, v12, v9
    v_fmac_f32 v14, v12, v13
    v_cvt_pk_bf16_f32 v9, 0, v14
    s_mov_b32 s58, 0xbfb8aa3b
    v_mul_f32 v12, s58, v10
    v_fma_f32 v13, v10, s58, -v12
    v_fmac_f32 v13, 0xb2a57060, v10
    v_min_f32 v12, 0x42fc0000, v12
    v_exp_f32 v12, v12
    v_mul_f32 v13, 0x3f317218, v13
    v_fmac_f32 v12, v12, v13
    v_add_f32 v12, 1.0, v12
    v_rcp_f32 v13, v12
    s_nop 0
    v_mul_f32 v14, v10, v13
    v_fma_f32 v12, -v14, v12, v10
    v_fmac_f32 v14, v12, v13
    v_cvt_pk_bf16_f32 v10, 0, v14
    v_perm_b32 v9, v10, v9, s61
    s_mov_b32 exec_hi, 0xffffff
    ds_write_b32 v3, v9
    s_mov_b32 exec_hi, -1
    ds_read_b128 v[8:11], v1
    ds_read_b96 v[12:14], v1 offset:16
    s_lshr_b32 s51, s50, 5
    s_lshl_b32 s51, s51, 13
    s_lshl_b32 s50, s50, 8
    s_add_u32 s50, s50, s51
    s_add_u32 s50, s50, 98304
    s_add_u32 s51, s50, 8192
    v_lshrrev_b32 v2, 4, v0
    v_and_b32 v3, 7, v0
    v_lshlrev_b32 v3, 4, v3
    v_lshl_add_u32 v2, v2, 7, v3
    s_waitcnt lgkmcnt(0)
    s_add_u32 s30, s30, 1
    s_and_b32 s34, s30, 0x7f
    s_xor_b32 s35, s34, 0x5a
    s_lshl_b32 s3, s35, 8
    s_or_b32 s3, s3, s34
    v_perm_b32 v15, v8, v8, s52
    v_and_b32 v16, v15, v4
    v_and_b32 v17, v15, v5
    v_and_b32 v18, v15, v6
    v_and_b32 v19, v15, v7
    v_perm_b32 v15, v8, v8, s53
    v_and_b32 v20, v15, v4
    v_and_b32 v21, v15, v5
    v_and_b32 v22, v15, v6
    v_and_b32 v23, v15, v7
    v_perm_b32 v15, v9, v9, s52
    v_and_b32 v24, v15, v4
    v_and_b32 v25, v15, v5
    v_and_b32 v26, v15, v6
    v_and_b32 v27, v15, v7
    v_perm_b32 v15, v9, v9, s53
    v_and_b32 v28, v15, v4
    v_and_b32 v29, v15, v5
    v_and_b32 v30, v15, v6
    v_and_b32 v31, v15, v7
    v_perm_b32 v15, v10, v10, s52
    v_and_b32 v32, v15, v4
    v_and_b32 v33, v15, v5
    v_and_b32 v34, v15, v6
    v_and_b32 v35, v15, v7
    v_perm_b32 v15, v10, v10, s53
    v_and_b32 v36, v15, v4
    v_and_b32 v37, v15, v5
    v_and_b32 v38, v15, v6
    v_and_b32 v39, v15, v7
    v_perm_b32 v15, v11, v11, s52
    v_and_b32 v40, v15, v4
    v_and_b32 v41, v15, v5
    v_and_b32 v42, v15, v6
    v_and_b32 v43, v15, v7
    v_perm_b32 v15, v11, v11, s53
    v_and_b32 v44, v15, v4
    v_and_b32 v45, v15, v5
    v_and_b32 v46, v15, v6
    v_and_b32 v47, v15, v7
    v_perm_b32 v15, v12, v12, s52
    v_and_b32 v48, v15, v4
    v_and_b32 v49, v15, v5
    v_and_b32 v50, v15, v6
    v_and_b32 v51, v15, v7
    v_perm_b32 v15, v12, v12, s53
    v_and_b32 v52, v15, v4
    v_and_b32 v53, v15, v5
    v_and_b32 v54, v15, v6
    v_and_b32 v55, v15, v7
    v_perm_b32 v15, v13, v13, s52
    v_and_b32 v56, v15, v4
    v_and_b32 v57, v15, v5
    v_and_b32 v58, v15, v6
    v_and_b32 v59, v15, v7
    v_perm_b32 v15, v13, v13, s53
    v_and_b32 v60, v15, v4
    v_and_b32 v61, v15, v5
    v_and_b32 v62, v15, v6
    v_and_b32 v63, v15, v7
    v_perm_b32 v15, v14, v14, s52
    v_and_b32 v64, v15, v4
    v_and_b32 v65, v15, v5
    v_and_b32 v66, v15, v6
    v_and_b32 v67, v15, v7
    v_perm_b32 v15, v14, v14, s53
    v_and_b32 v68, v15, v4
    v_and_b32 v69, v15, v5
    v_and_b32 v70, v15, v6
    v_and_b32 v71, v15, v7
    v_and_b32_e64 v4, s34, 3
    v_and_b32_e64 v5, s35, 3
    s_waitcnt vmcnt(13)
    v_mfma_f32_16x16x32_bf16 v[8:11], v[16:19], v[72:75], 0
    s_waitcnt vmcnt(12)
    v_mfma_f32_16x16x32_bf16 v[8:11], v[20:23], v[76:79], v[8:11]
    s_waitcnt vmcnt(11)
    v_mfma_f32_16x16x32_bf16 v[8:11], v[24:27], v[80:83], v[8:11]
    s_waitcnt vmcnt(10)
    v_mfma_f32_16x16x32_bf16 v[8:11], v[28:31], v[84:87], v[8:11]
    s_waitcnt vmcnt(9)
    v_mfma_f32_16x16x32_bf16 v[8:11], v[32:35], v[88:91], v[8:11]
    s_waitcnt vmcnt(8)
    v_mfma_f32_16x16x32_bf16 v[8:11], v[36:39], v[92:95], v[8:11]
    s_waitcnt vmcnt(7)
    v_mfma_f32_16x16x32_bf16 v[8:11], v[40:43], v[96:99], v[8:11]
    s_waitcnt vmcnt(6)
    v_mfma_f32_16x16x32_bf16 v[8:11], v[44:47], v[100:103], v[8:11]
    s_waitcnt vmcnt(5)
    v_mfma_f32_16x16x32_bf16 v[8:11], v[48:51], v[104:107], v[8:11]
    s_waitcnt vmcnt(4)
    v_mfma_f32_16x16x32_bf16 v[8:11], v[52:55], v[108:111], v[8:11]
    s_waitcnt vmcnt(3)
    v_mfma_f32_16x16x32_bf16 v[8:11], v[56:59], v[112:115], v[8:11]
    s_waitcnt vmcnt(2)
    v_mfma_f32_16x16x32_bf16 v[8:11], v[60:63], v[116:119], v[8:11]
    s_waitcnt vmcnt(1)
    v_mfma_f32_16x16x32_bf16 v[8:11], v[64:67], v[120:123], v[8:11]
    s_waitcnt vmcnt(0)
    v_mfma_f32_16x16x32_bf16 v[8:11], v[68:71], v[124:127], v[8:11]
    s_nop 7
    v_pk_mov_b32 v[12:13], v[8:9], v[8:9] op_sel:[0,1]
    v_pk_mov_b32 v[14:15], v[10:11], v[10:11] op_sel:[0,1]
    s_nop 0
    v_permlane32_swap_b32 v8, v12
    v_permlane32_swap_b32 v9, v13
    v_permlane32_swap_b32 v10, v14
    v_permlane32_swap_b32 v11, v15
    v_add_f32_dpp v8, v12, v8 row_ror:8 row_mask:0xf bank_mask:0xf
    v_add_f32_dpp v9, v13, v9 row_ror:8 row_mask:0xf bank_mask:0xf
    v_add_f32_dpp v10, v14, v10 row_ror:8 row_mask:0xf bank_mask:0xf
    v_add_f32_dpp v11, v15, v11 row_ror:8 row_mask:0xf bank_mask:0xf
    s_mov_b64 exec, 0xff00ff
    v_add_u32 v8, 2, v8
    v_add_u32 v9, 2, v9
    v_add_u32 v10, 2, v10
    v_add_u32 v11, 2, v11
    v_and_or_b32 v8, v8, -4, v4
    v_and_or_b32 v9, v9, -4, v5
    v_and_or_b32 v10, v10, -4, v4
    v_and_or_b32 v11, v11, -4, v5
    buffer_store_dwordx4 v[8:11], v2, s[44:47], s50 offen sc1
    buffer_store_dwordx4 v[8:11], v2, s[44:47], s51 offen sc1
    s_mov_b64 exec, -1
    s_setprio 0
    s_cmp_lt_u32 s33, 14
    s_cbranch_scc1 L_t_go2
    s_endpgm
.p2align 12
L_T:
    v_and_b32 v0, 63, v0
    s_cmp_eq_u32 s31, 13
    s_cbranch_scc0 L_T1
    s_mul_i32 s50, s33, 19
    s_lshl_b32 s51, s32, 10
    v_add_u32 v2, s50, v0
    v_min_u32 v2, 447, v2
    v_lshl_add_u32 v2, v2, 13, s51
    s_mov_b64 exec, 0x7ffff
    global_load_dword v127, v2, s[10:11] offset:384
    s_mov_b64 exec, -1
L_T1:
    s_cmp_lt_u32 s33, 14
    s_cbranch_scc1 L_t_go
    s_cmp_eq_u32 s31, 8
    s_cbranch_scc1 L_t_go
    s_branch L_pf
L_t_go:
    s_waitcnt lgkmcnt(0)
L_t_go2:
    s_load_dword s30, s[28:29], 0
    s_sub_u32 s49, s31, 8
    s_mov_b32 s44, s28
    s_mov_b32 s45, s29
    s_mov_b32 s46, 1441792
    s_mov_b32 s47, 0x20000
    s_mov_b32 s60, 0x05040100
    s_mov_b32 s61, 0x07060302
    s_lshl_b32 s56, s49, 8
    s_add_u32 s56, s56, 20480
    s_cmp_ge_u32 s33, 7
    s_cselect_b32 s50, 1, 0
    s_cselect_b32 s51, 7, 0
    s_sub_u32 s51, s33, s51
    s_lshl_b32 s52, s32, 1
    s_add_u32 s50, s50, s52
    s_lshl_b32 s52, s50, 8
    s_lshr_b32 s53, s49, 2
    s_lshl_b32 s53, s53, 7
    s_add_u32 s52, s52, s53
    s_and_b32 s53, s49, 1
    s_lshl_b32 s53, s53, 6
    s_add_u32 s52, s52, s53
    s_and_b32 s53, s49, 2
    s_lshl_b32 s53, s53, 1
    s_add_u32 s52, s52, s53
    s_mul_i32 s52, s52, 896
    s_lshl_b32 s53, s51, 7
    s_add_u32 s52, s52, s53
    s_add_u32 s53, s52, 7168
    s_mov_b32 s36, s12
    s_mov_b32 s37, s13
    s_mov_b32 s38, 3670016
    s_mov_b32 s39, 0x20000
    s_mul_i32 s40, s50, 24576
    s_lshl_b32 s41, s49, 7
    s_add_u32 s40, s40, s41
    s_add_u32 s40, s40, 1048576
    s_add_u32 s41, s40, 8192
    s_add_u32 s42, s40, 16384
    s_lshr_b32 s54, s50, 2
    s_lshl_b32 s54, s54, 13
    s_lshl_b32 s55, s50, 11
    s_add_u32 s54, s54, s55
    s_lshl_b32 s55, s51, 8
    s_add_u32 s54, s54, s55
    s_add_u32 s54, s54, 196608
    s_add_u32 s55, s54, 8192
    s_mov_b32 s43, 0
    s_mov_b32 s57, 0x04000c0c
    s_mov_b32 s58, 0x3db8aa3b
    s_lshl_b32 s59, s49, 8
    s_add_u32 s59, s59, 22528
    v_lshrrev_b32 v12, 3, v0
    v_and_b32 v13, 7, v0
    v_lshlrev_b32 v3, 10, v12
    v_lshl_add_u32 v3, v13, 4, v3
    v_lshrrev_b32 v5, 4, v0
    v_lshl_add_u32 v5, v13, 2, v5
    v_lshl_add_u32 v5, v5, 1, s56
    v_lshl_add_u32 v6, v0, 4, s59
    v_lshlrev_b32 v4, 2, v0
    v_lshrrev_b32 v12, 4, v0
    v_mul_u32_u24 v1, 14336, v12
    v_bfe_u32 v12, v0, 3, 1
    v_mul_u32_u24 v12, 896, v12
    v_add_u32 v1, v1, v12
    v_and_b32 v12, 7, v0
    v_lshl_add_u32 v1, v12, 4, v1
    v_lshrrev_b32 v12, 4, v0
    v_lshlrev_b32 v12, 4, v12
    v_add_u32 v12, s56, v12
    v_and_b32 v13, 1, v0
    v_mov_b32 v14, 2368
    v_cmp_eq_u32 vcc, 0, v13
    s_nop 1
    v_cndmask_b32 v8, v14, v12, vcc
    v_cmp_eq_u32 vcc, 1, v13
    s_nop 1
    v_cndmask_b32 v9, v14, v12, vcc
    s_waitcnt lgkmcnt(0)
    s_add_u32 s30, s30, 1
    s_and_b32 s34, s30, 0x7f
    s_xor_b32 s35, s34, 0x5a
    s_lshl_b32 s3, s35, 8
    s_or_b32 s3, s3, s34
    v_bfe_u32 v7, v0, 0, 1
    v_mul_u32_u24 v7, 0x5a, v7
    v_xor_b32 v7, s34, v7
    v_bfe_u32 v99, v0, 2, 1
    v_mul_u32_u24 v99, 0x5a, v99
    v_xor_b32 v99, s34, v99
    v_and_b32 v98, 3, v0
    v_cmp_eq_u32 vcc, 0, v98
    v_mov_b32 v98, 0xffffff00
    s_nop 0
    v_cndmask_b32 v99, 0, v99, vcc
    v_cndmask_b32 v98, -1, v98, vcc
    v_and_b32 v10, 3, v0
    v_lshlrev_b32 v10, 3, v10
    v_lshlrev_b32_e64 v10, v10, 12
    v_xor_b32 v10, 0x0c0c0c0c, v10
    s_cmp_eq_u32 s49, 0
    s_cbranch_scc0 L_wo
    v_lshlrev_b32 v2, 4, v0
    s_lshl_b32 s4, s32, 11
    s_add_u32 s4, s4, 32768
    s_mov_b32 m0, 0
    s_mov_b32 s62, 0
    s_setprio 3
L_p_loop:
    buffer_load_dwordx4 v2, s[44:47], s4 offen sc1 lds
    buffer_load_dwordx4 v2, s[44:47], s4 offen offset:1024 sc1 lds
    s_sleep 8
    s_cmp_eq_u32 s62, 262144
    s_cselect_b32 s5, 16384, 0
    s_sub_u32 s4, s4, s5
    ds_read2st64_b32 v[12:13], v2 offset0:0 offset1:4
    s_waitcnt vmcnt(32) lgkmcnt(0)
    v_bitop3_b32 v12, v12, v13, s3 bitop3:0x7e
    v_cmp_ne_u32_sdwa vcc, v12, 0 src0_sel:WORD_0 src1_sel:DWORD
    s_cbranch_vccz L_p_ok
    s_add_u32 s62, s62, 4096
    s_cbranch_scc0 L_p_loop
L_p_ok:
    s_setprio 0
    s_cmp_lt_u32 s33, 14
    s_cbranch_scc0 L_fin
    s_branch L_wo
L_a_qr:
    s_cmp_eq_u32 s63, 0
    s_cbranch_scc0 L_a_qr0
    s_waitcnt vmcnt(6)
    global_load_dwordx4 v[88:91], v7, s[42:43] offset:-4096 nt
    s_mov_b32 s63, 1
    s_branch L_a_q
L_a_qr0:
    s_cmp_eq_u32 s63, 1
    s_cbranch_scc0 L_a_qr1
    s_waitcnt vmcnt(6)
    global_load_dwordx4 v[92:95], v7, s[42:43] offset:-3840 nt
    s_mov_b32 s63, 2
    s_branch L_a_q
L_a_qr1:
    s_cmp_eq_u32 s63, 2
    s_cbranch_scc0 L_a_qr2
    s_waitcnt vmcnt(6)
    global_load_dwordx4 v[96:99], v7, s[42:43] offset:-2048 nt
    s_mov_b32 s63, 3
    s_branch L_a_q
L_a_qr2:
    s_cmp_eq_u32 s63, 3
    s_cbranch_scc0 L_a_qr3
    s_waitcnt vmcnt(6)
    global_load_dwordx4 v[100:103], v7, s[42:43] offset:-1792 nt
    s_mov_b64 exec, 1
    ds_inc_u32 v0, v2 offset:2064
    s_mov_b64 exec, -1
    s_cmp_eq_u32 s31, 0
    s_cbranch_scc0 L_a_nhb
    v_mov_b32 v114, s3
    s_mov_b64 exec, 1
    buffer_store_dword v114, v0, s[44:47], s59 offen
    s_mov_b64 exec, -1
L_a_nhb:
    s_mov_b32 s63, 4
    s_branch L_a_q
L_a_qr3:
    s_sleep 1
    s_add_u32 s62, s62, 4096
    s_cbranch_scc0 L_a_q
    s_branch L_a_qok
L_a_q0:
    s_setprio 2
L_a_q:
    ds_read_b128 v[104:107], v1 offset:0
    ds_read_b128 v[108:111], v1 offset:16
    ds_read_b128 v[112:115], v1 offset:512
    ds_read_b128 v[116:119], v1 offset:528
    s_waitcnt lgkmcnt(0)
    v_bitop3_b32 v120, v104, v108, s3 bitop3:0x7e
    v_bitop3_b32 v121, v112, v116, s3 bitop3:0x7e
    v_or_b32 v121, v120, v121
    v_cmp_ne_u32_sdwa vcc, v121, 0 src0_sel:WORD_0 src1_sel:DWORD
    v_perm_b32 v120, v105, v104, s61
    v_perm_b32 v121, v107, v106, s61
    v_perm_b32 v122, v109, v108, s61
    v_perm_b32 v123, v111, v110, s61
    v_perm_b32 v124, v113, v112, s61
    v_perm_b32 v125, v115, v114, s61
    v_perm_b32 v126, v117, v116, s61
    v_perm_b32 v127, v119, v118, s61
    s_cbranch_vccnz L_a_qr
L_a_qok:
    s_cmp_gt_u32 s63, 0
    s_cbranch_scc1 L_a_l0
    s_waitcnt vmcnt(6)
    global_load_dwordx4 v[88:91], v7, s[42:43] offset:-4096 nt
L_a_l0:
    s_waitcnt vmcnt(7)
    s_cmp_eq_u32 s51, 0
    s_cbranch_scc1 L_a_qk1
    v_mfma_f32_16x16x32_bf16 v[104:107], v[8:11], v[120:123], 0
    v_mfma_f32_16x16x32_bf16 v[8:11], v[12:15], v[124:127], v[104:107]
L_a_qk1:
    v_mfma_f32_16x16x32_bf16 v[108:111], v[16:19], v[120:123], 0
    v_mov_b32 v1, 0
    v_mfma_f32_16x16x32_bf16 v[16:19], v[20:23], v[124:127], v[108:111]
    s_mov_b32 s62, 0
    v_mfma_f32_16x16x32_bf16 v[112:115], v[24:27], v[120:123], 0
    s_lshl_b32 s48, s57, 3
    v_mfma_f32_16x16x32_bf16 v[24:27], v[28:31], v[124:127], v[112:115]
    s_lshl_b32 s49, s31, 2
    v_mfma_f32_16x16x32_bf16 v[116:119], v[32:35], v[120:123], 0
    v_mov_b32_dpp v12, v8 quad_perm:[0,0,0,0] row_mask:0xf bank_mask:0xf
    v_mfma_f32_16x16x32_bf16 v[32:35], v[36:39], v[124:127], v[116:119]
    s_nop 0
    v_add_f32_dpp v12, v9, v12 quad_perm:[1,1,1,1] row_mask:0xf bank_mask:0xf
    s_cmp_gt_u32 s63, 1
    s_cbranch_scc1 L_a_l1
    s_waitcnt vmcnt(6)
    global_load_dwordx4 v[92:95], v7, s[42:43] offset:-3840 nt
L_a_l1:
    v_mfma_f32_16x16x32_bf16 v[104:107], v[40:43], v[120:123], 0
    v_mov_b32_dpp v20, v16 quad_perm:[0,0,0,0] row_mask:0xf bank_mask:0xf
    v_add_f32_dpp v12, v10, v12 quad_perm:[2,2,2,2] row_mask:0xf bank_mask:0xf
    v_mfma_f32_16x16x32_bf16 v[40:43], v[44:47], v[124:127], v[104:107]
    v_add_f32_dpp v20, v17, v20 quad_perm:[1,1,1,1] row_mask:0xf bank_mask:0xf
    v_add_f32_dpp v12, v11, v12 quad_perm:[3,3,3,3] row_mask:0xf bank_mask:0xf
    v_mfma_f32_16x16x32_bf16 v[108:111], v[48:51], v[120:123], 0
    v_mov_b32_dpp v28, v24 quad_perm:[0,0,0,0] row_mask:0xf bank_mask:0xf
    v_add_f32_dpp v20, v18, v20 quad_perm:[2,2,2,2] row_mask:0xf bank_mask:0xf
    v_mfma_f32_16x16x32_bf16 v[48:51], v[52:55], v[124:127], v[108:111]
    v_add_f32_dpp v28, v25, v28 quad_perm:[1,1,1,1] row_mask:0xf bank_mask:0xf
    v_add_f32_dpp v20, v19, v20 quad_perm:[3,3,3,3] row_mask:0xf bank_mask:0xf
    s_cmp_gt_u32 s63, 2
    s_cbranch_scc1 L_a_l2
    s_waitcnt vmcnt(6)
    global_load_dwordx4 v[96:99], v7, s[42:43] offset:-2048 nt
L_a_l2:
    v_add_f32_dpp v28, v26, v28 quad_perm:[2,2,2,2] row_mask:0xf bank_mask:0xf
    v_mov_b32_dpp v36, v32 quad_perm:[0,0,0,0] row_mask:0xf bank_mask:0xf
    v_mov_b32_dpp v44, v40 quad_perm:[0,0,0,0] row_mask:0xf bank_mask:0xf
    v_add_f32_dpp v28, v27, v28 quad_perm:[3,3,3,3] row_mask:0xf bank_mask:0xf
    v_add_f32_dpp v36, v33, v36 quad_perm:[1,1,1,1] row_mask:0xf bank_mask:0xf
    v_add_f32_dpp v44, v41, v44 quad_perm:[1,1,1,1] row_mask:0xf bank_mask:0xf
    v_cvt_pk_bf16_f32 v12, 0, v12
    s_waitcnt vmcnt(7)
    v_and_b32 v6, 8, v0
    v_mov_b32_dpp v52, v48 quad_perm:[0,0,0,0] row_mask:0xf bank_mask:0xf
    v_add_f32_dpp v36, v34, v36 quad_perm:[2,2,2,2] row_mask:0xf bank_mask:0xf
    v_add_f32_dpp v44, v42, v44 quad_perm:[2,2,2,2] row_mask:0xf bank_mask:0xf
    v_add_f32_dpp v52, v49, v52 quad_perm:[1,1,1,1] row_mask:0xf bank_mask:0xf
    v_add_f32_dpp v36, v35, v36 quad_perm:[3,3,3,3] row_mask:0xf bank_mask:0xf
    v_add_f32_dpp v44, v43, v44 quad_perm:[3,3,3,3] row_mask:0xf bank_mask:0xf
    v_add_f32_dpp v52, v50, v52 quad_perm:[2,2,2,2] row_mask:0xf bank_mask:0xf
    v_cvt_pk_bf16_f32 v20, 0, v20
    v_cvt_pk_bf16_f32 v28, 0, v28
    v_add_f32_dpp v52, v51, v52 quad_perm:[3,3,3,3] row_mask:0xf bank_mask:0xf
    v_cvt_pk_bf16_f32 v36, 0, v36
    v_cvt_pk_bf16_f32 v44, 0, v44
    v_max3_f32 v112, v12, v20, v28
    v_cvt_pk_bf16_f32 v52, 0, v52
    v_max3_f32 v112, v112, v36, v44
    s_mov_b32 exec_lo, 0x01010101
    s_mov_b32 exec_hi, 0x01010101
    v_max_f32 v112, v112, v52
    ds_max_f32 v6, v112 offset:2048
    s_mov_b64 exec, 1
    ds_inc_u32 v0, v2 offset:2068
    s_mov_b64 exec, -1
    v_mov_b32 v117, s48
    s_cmp_gt_u32 s63, 3
    s_cbranch_scc1 L_a_l3
    s_waitcnt vmcnt(6)
    global_load_dwordx4 v[100:103], v7, s[42:43] offset:-1792 nt
    s_mov_b64 exec, 1
    ds_inc_u32 v0, v2 offset:2064
    s_mov_b64 exec, -1
    s_cmp_eq_u32 s31, 0
    s_cbranch_scc0 L_a_nha
    v_mov_b32 v114, s3
    s_mov_b64 exec, 1
    buffer_store_dword v114, v0, s[44:47], s59 offen
    s_mov_b64 exec, -1
L_a_nha:
L_a_l3:
L_a_s1:
    ds_read_b32 v113, v1 offset:2068
    ds_read_b32 v112, v6 offset:2048
    ds_read_b32 v116, v117 offset:2048
    s_waitcnt lgkmcnt(0)
    v_cmp_ne_u32 vcc, 8, v113
    v_mul_f32 v112, s58, v112
    v_fma_f32 v22, v20, s58, -v112
    v_fma_f32 v14, v12, s58, -v112
    v_fma_f32 v30, v28, s58, -v112
    v_fma_f32 v38, v36, s58, -v112
    v_fma_f32 v46, v44, s58, -v112
    v_fma_f32 v54, v52, s58, -v112
    s_cbranch_vccnz L_a_s1r
L_a_s1ok:
    v_exp_f32 v20, v22
    v_exp_f32 v12, v14
    v_exp_f32 v28, v30
    v_exp_f32 v36, v38
    v_exp_f32 v44, v46
    v_exp_f32 v52, v54
    v_cvt_pk_bf16_f32 v21, v20, v20
    v_and_b32 v16, v21, v2
    v_and_b32 v17, v21, v3
    v_and_b32 v18, v21, v4
    v_and_b32 v19, v21, v5
    v_add_f32 v113, v12, v20
    v_add_f32 v114, v28, v36
    v_mfma_f32_16x16x32_bf16 v[104:107], v[16:19], v[64:67], 0
    v_cvt_pk_bf16_f32 v29, v28, v28
    v_and_b32 v24, v29, v2
    v_and_b32 v25, v29, v3
    v_and_b32 v26, v29, v4
    v_and_b32 v27, v29, v5
    v_mfma_f32_16x16x32_bf16 v[108:111], v[16:19], v[68:71], 0
    s_cmp_eq_u32 s51, 0
    s_cbranch_scc1 L_a_pv2
    v_cvt_pk_bf16_f32 v13, v12, v12
    v_and_b32 v8, v13, v2
    v_and_b32 v9, v13, v3
    v_and_b32 v10, v13, v4
    v_and_b32 v11, v13, v5
    s_nop 1
    v_mfma_f32_16x16x32_bf16 v[104:107], v[8:11], v[56:59], v[104:107]
    v_mfma_f32_16x16x32_bf16 v[108:111], v[8:11], v[60:63], v[108:111]
L_a_pv2:
    v_cvt_pk_bf16_f32 v37, v36, v36
    v_and_b32 v32, v37, v2
    v_and_b32 v33, v37, v3
    v_and_b32 v34, v37, v4
    v_and_b32 v35, v37, v5
    v_mfma_f32_16x16x32_bf16 v[104:107], v[24:27], v[72:75], v[104:107]
    v_cvt_pk_bf16_f32 v45, v44, v44
    v_and_b32 v40, v45, v2
    v_and_b32 v41, v45, v3
    v_and_b32 v42, v45, v4
    v_and_b32 v43, v45, v5
    v_cvt_pk_bf16_f32 v53, v52, v52
    v_and_b32 v48, v53, v2
    v_and_b32 v49, v53, v3
    v_and_b32 v50, v53, v4
    v_and_b32 v51, v53, v5
    v_add_f32 v115, v44, v52
    v_add_f32 v113, v113, v114
    v_lshl_add_u32 v6, v6, 2, s49
    v_add_f32 v113, v113, v115
    v_mov_b32 v114, v113
    s_nop 1
    v_permlane32_swap_b32 v113, v114
    v_add_f32 v113, v113, v114
    v_mov_b32 v114, v113
    s_nop 1
    v_permlane16_swap_b32 v113, v114
    v_add_f32 v113, v113, v114
    s_mov_b64 exec, 0x101
    ds_write_b32 v6, v113 offset:2112
    s_mov_b64 exec, -1
    s_lshl_b32 s48, s31, 11
    v_lshl_add_u32 v6, v0, 4, s48
    v_bfe_u32 v119, v0, 2, 1
    v_mul_u32_u24 v119, 0x5a, v119
    v_and_b32 v120, 3, v0
    v_cmp_eq_u32 vcc, 1, v120
    v_bitop3_b32 v119, v119, v116, s34 bitop3:0xde
    v_bfe_u32 v118, v0, 2, 2
    v_cndmask_b32 v120, v120, v118, vcc
    v_cndmask_b32_e64 v119, v119, 0, vcc
    v_cndmask_b32_e64 v118, 0, -1, vcc
    v_or_b32 v120, 0x07060500, v120
    s_lshl_b32 s49, s31, 8
    s_add_u32 s49, s49, 4096
    v_lshlrev_b32 v121, 2, v0
    v_add_u32 v122, s49, v121
    v_lshlrev_b32 v117, 2, v117
    s_mov_b32 s62, 0
    s_and_b32 s48, s31, 5
    s_waitcnt vmcnt(6)
    v_mfma_f32_16x16x32_bf16 v[108:111], v[24:27], v[76:79], v[108:111]
    s_waitcnt vmcnt(5)
    v_mfma_f32_16x16x32_bf16 v[104:107], v[32:35], v[80:83], v[104:107]
    s_waitcnt vmcnt(4)
    v_mfma_f32_16x16x32_bf16 v[108:111], v[32:35], v[84:87], v[108:111]
    s_waitcnt vmcnt(3)
    v_mfma_f32_16x16x32_bf16 v[104:107], v[40:43], v[88:91], v[104:107]
    s_waitcnt vmcnt(2)
    v_mfma_f32_16x16x32_bf16 v[108:111], v[40:43], v[92:95], v[108:111]
    s_waitcnt vmcnt(1)
    v_mfma_f32_16x16x32_bf16 v[104:107], v[48:51], v[96:99], v[104:107]
    s_waitcnt vmcnt(0)
    v_mfma_f32_16x16x32_bf16 v[108:111], v[48:51], v[100:103], v[108:111]
    s_nop 5
    ds_write_b128 v6, v[104:107] offset:4096
    s_nop 0
    ds_write_b128 v6, v[108:111] offset:5120
    s_waitcnt lgkmcnt(0)
    s_barrier
    ds_read2st64_b32 v[8:9], v122 offset0:0 offset1:8
    ds_read2st64_b32 v[10:11], v122 offset0:16 offset1:24
    ds_read2st64_b32 v[12:13], v122 offset0:32 offset1:40
    ds_read2st64_b32 v[14:15], v122 offset0:48 offset1:56
    s_cbranch_scc1 L_a_nl
    ds_read_b128 v[16:19], v117 offset:2112
    ds_read_b128 v[20:23], v117 offset:2128
    s_waitcnt lgkmcnt(0)
    v_pk_add_f32 v[16:17], v[16:17], v[18:19]
    v_pk_add_f32 v[20:21], v[20:21], v[22:23]
    v_pk_add_f32 v[16:17], v[16:17], v[20:21]
    v_add_f32 v16, v16, v17
    v_bfi_b32 v119, v118, v16, v119
L_a_nl:
    s_waitcnt lgkmcnt(0)
    v_pk_add_f32 v[8:9], v[8:9], v[10:11]
    v_pk_add_f32 v[12:13], v[12:13], v[14:15]
    v_pk_add_f32 v[8:9], v[8:9], v[12:13]
    v_add_f32 v8, v8, v9
    v_perm_b32 v8, v8, v119, v120
    buffer_store_dword v8, v121, s[44:47], s55 offen
    s_barrier
    s_setprio 0
    s_barrier
    s_cmp_lt_u32 s33, 14
    s_cbranch_scc0 L_a_x
    s_mov_b32 s62, 0
L_a_b:
    s_sleep 4
    ds_read_b32 v24, v1 offset:2084
    s_add_u32 s62, s62, 0x20000000
    s_cbranch_scc1 L_a_x
    s_waitcnt lgkmcnt(0)
    v_cmp_eq_u32 vcc, 0, v24
    s_cbranch_vccnz L_a_b
L_a_x:
    buffer_store_dword v8, v121, s[44:47], s54 offen sc1
    s_endpgm
L_a_s1r:
    s_add_u32 s62, s62, 4096
    s_cbranch_scc0 L_a_s1
    s_branch L_a_s1ok
L_wo:
    v_mov_b32 v100, 0
    s_mov_b32 s62, 0
L_wo_g:
    s_sleep 2
    ds_read_b32 v101, v100 offset:2064
    s_waitcnt lgkmcnt(0)
    v_cmp_gt_u32 vcc, 8, v101
    s_cbranch_vccz L_wo_gok
    s_add_u32 s62, s62, 4096
    s_cbranch_scc0 L_wo_g
L_wo_gok:
    buffer_load_dwordx4 v[80:83], v1, s[36:39], s52 offen offset:0 nt
    buffer_load_dwordx4 v[84:87], v1, s[36:39], s52 offen offset:1792 nt
    buffer_load_dwordx4 v[88:91], v1, s[36:39], s53 offen offset:0 nt
    buffer_load_dwordx4 v[92:95], v1, s[36:39], s53 offen offset:1792 nt
    s_setprio 3
    s_barrier
    s_barrier
    buffer_load_dwordx4 v[32:35], v3, s[44:47], s40 offen sc1
    buffer_load_dwordx4 v[36:39], v3, s[44:47], s41 offen sc1
    buffer_load_dwordx4 v[40:43], v3, s[44:47], s42 offen sc1
    s_waitcnt vmcnt(3)
    v_pk_mov_b32 v[48:49], v[82:83], v[82:83] op_sel:[0,1]
    v_pk_mov_b32 v[50:51], v[86:87], v[86:87] op_sel:[0,1]
    v_mov_b32_dpp v82, v80 row_ror:8 row_mask:0xf bank_mask:0x3
    v_mov_b32_dpp v83, v81 row_ror:8 row_mask:0xf bank_mask:0x3
    v_mov_b32_dpp v86, v84 row_ror:8 row_mask:0xf bank_mask:0x3
    v_mov_b32_dpp v87, v85 row_ror:8 row_mask:0xf bank_mask:0x3
    v_mov_b32_dpp v80, v48 row_ror:8 row_mask:0xf bank_mask:0xc
    v_mov_b32_dpp v81, v49 row_ror:8 row_mask:0xf bank_mask:0xc
    v_mov_b32_dpp v84, v50 row_ror:8 row_mask:0xf bank_mask:0xc
    v_mov_b32_dpp v85, v51 row_ror:8 row_mask:0xf bank_mask:0xc
    v_pk_mov_b32 v[48:49], v[90:91], v[90:91] op_sel:[0,1]
    v_pk_mov_b32 v[50:51], v[94:95], v[94:95] op_sel:[0,1]
    v_mov_b32_dpp v90, v88 row_ror:8 row_mask:0xf bank_mask:0x3
    v_mov_b32_dpp v91, v89 row_ror:8 row_mask:0xf bank_mask:0x3
    v_mov_b32_dpp v94, v92 row_ror:8 row_mask:0xf bank_mask:0x3
    v_mov_b32_dpp v95, v93 row_ror:8 row_mask:0xf bank_mask:0x3
    v_mov_b32_dpp v88, v48 row_ror:8 row_mask:0xf bank_mask:0xc
    v_mov_b32_dpp v89, v49 row_ror:8 row_mask:0xf bank_mask:0xc
    v_mov_b32_dpp v92, v50 row_ror:8 row_mask:0xf bank_mask:0xc
    v_mov_b32_dpp v93, v51 row_ror:8 row_mask:0xf bank_mask:0xc
    v_perm_b32 v16, v82, v80, s60
    v_perm_b32 v17, v86, v84, s60
    v_perm_b32 v18, v90, v88, s60
    v_perm_b32 v19, v94, v92, s60
    v_perm_b32 v20, v82, v80, s61
    v_perm_b32 v21, v86, v84, s61
    v_perm_b32 v22, v90, v88, s61
    v_perm_b32 v23, v94, v92, s61
    v_perm_b32 v24, v83, v81, s60
    v_perm_b32 v25, v87, v85, s60
    v_perm_b32 v26, v91, v89, s60
    v_perm_b32 v27, v95, v93, s60
    v_perm_b32 v28, v83, v81, s61
    v_perm_b32 v29, v87, v85, s61
    v_perm_b32 v30, v91, v89, s61
    v_perm_b32 v31, v95, v93, s61
    s_mov_b32 s62, 0
    s_mov_b32 s63, 33554432
    s_branch L_x3_w
.p2align 6
    s_nop 0
    s_nop 0
L_x3:
    s_wqm_b64 exec, s[4:5]
    s_cbranch_scc0 L_x3_z0
    buffer_load_dwordx4 v[32:35], v3, s[44:47], s40 offen sc1
L_x3_z0:
    s_wqm_b64 exec, s[6:7]
    s_cbranch_scc0 L_x3_z1
    buffer_load_dwordx4 v[36:39], v3, s[44:47], s41 offen sc1
L_x3_z1:
    s_wqm_b64 exec, s[8:9]
    s_cbranch_scc0 L_x3_z2
    buffer_load_dwordx4 v[40:43], v3, s[44:47], s42 offen sc1
L_x3_z2:
    s_mov_b64 exec, -1
    s_add_u32 s62, s62, s63
    s_cbranch_scc1 L_x3_r
L_x3_w:
    s_waitcnt vmcnt(0)
    v_cmp_ne_u32_sdwa s[4:5], v32, v7 src0_sel:BYTE_0 src1_sel:DWORD
    v_cmp_ne_u32_sdwa s[6:7], v36, v7 src0_sel:BYTE_0 src1_sel:DWORD
    v_cmp_ne_u32_sdwa s[8:9], v40, v7 src0_sel:BYTE_0 src1_sel:DWORD
    v_perm_b32 v48, v35, v34, s57
    v_perm_b32 v50, v39, v38, s57
    v_perm_b32 v52, v43, v42, s57
    s_or_b64 vcc, s[4:5], s[6:7]
    s_or_b64 vcc, vcc, s[8:9]
    s_cbranch_scc1 L_x3
L_x3_ok:
    v_max3_f32 v54, v48, v50, v52
    v_xor_b32 v32, v32, v7
    v_xor_b32 v36, v36, v7
    v_max_f32_dpp v54, v54, v54 row_ror:8 row_mask:0xf bank_mask:0xf
    v_mov_b32 v55, v54
    v_xor_b32 v40, v40, v7
    s_nop 0
    v_permlane32_swap_b32 v54, v55
    v_max_f32 v54, v54, v55
    v_mov_b32 v55, v54
    s_nop 1
    v_permlane16_swap_b32 v54, v55
    v_max_f32 v54, v54, v55
    v_mul_f32 v54, s58, v54
    v_fma_f32 v56, v48, s58, -v54
    v_fma_f32 v58, v50, s58, -v54
    v_fma_f32 v60, v52, s58, -v54
    v_exp_f32 v56, v56
    v_exp_f32 v58, v58
    v_exp_f32 v60, v60
    v_pk_mul_f32 v[44:45], v[32:33], v[56:57] op_sel_hi:[1,0]
    v_pk_mul_f32 v[46:47], v[34:35], v[56:57] op_sel_hi:[1,0]
    v_pk_fma_f32 v[44:45], v[36:37], v[58:59], v[44:45] op_sel_hi:[1,0,1]
    v_pk_fma_f32 v[46:47], v[38:39], v[58:59], v[46:47] op_sel_hi:[1,0,1]
    v_pk_fma_f32 v[44:45], v[40:41], v[60:61], v[44:45] op_sel_hi:[1,0,1]
    v_pk_fma_f32 v[46:47], v[42:43], v[60:61], v[46:47] op_sel_hi:[1,0,1]
    s_nop 1
    v_permlane32_swap_b32 v44, v46
    v_permlane32_swap_b32 v45, v47
    v_pk_add_f32 v[44:45], v[44:45], v[46:47]
    s_nop 1
    v_permlane16_swap_b32 v44, v45
    v_add_f32 v44, v44, v45
    s_cmp_eq_u32 s49, 0
    s_nop 0
    v_add_f32_dpp v44, v44, v44 row_ror:8 row_mask:0xf bank_mask:0xf
    v_cvt_pk_bf16_f32 v44, 0, v44
    ds_write_b16_d16_hi v5, v44
    ds_read_b128 v[64:67], v8
    ds_read_b128 v[68:71], v9
    s_cbranch_scc1 L_wo_0
    s_cmp_eq_u32 s43, 0
    s_waitcnt lgkmcnt(1)
    v_mfma_f32_16x16x32_bf16 v[72:75], v[64:67], v[16:19], 0
    v_mfma_f32_16x16x32_bf16 v[76:79], v[64:67], v[24:27], 0
    s_waitcnt lgkmcnt(0)
    v_mfma_f32_16x16x32_bf16 v[72:75], v[68:71], v[20:23], v[72:75]
    v_mfma_f32_16x16x32_bf16 v[76:79], v[68:71], v[28:31], v[76:79]
    s_mov_b64 exec, 0xffff
    s_nop 6
    ds_write_b128 v6, v[74:77]
    s_mov_b64 exec, 1
    ds_inc_u32 v0, v98 offset:2080
    s_cbranch_scc0 L_wo_nb
    s_barrier
L_wo_nb:
    s_endpgm
L_wo_0:
    v_perm_b32 v48, v33, v33, v10
    v_perm_b32 v49, v37, v37, v10
    v_perm_b32 v50, v41, v41, v10
    v_or_b32_dpp v48, v48, v48 quad_perm:[1,0,3,2] row_mask:0xf bank_mask:0xf
    v_or_b32_dpp v49, v49, v49 quad_perm:[1,0,3,2] row_mask:0xf bank_mask:0xf
    v_or_b32_dpp v50, v50, v50 quad_perm:[1,0,3,2] row_mask:0xf bank_mask:0xf
    s_cmp_eq_u32 s43, 0
    s_waitcnt lgkmcnt(1)
    v_mfma_f32_16x16x32_bf16 v[72:75], v[64:67], v[16:19], 0
    v_or_b32_dpp v48, v48, v48 quad_perm:[2,3,0,1] row_mask:0xf bank_mask:0xf
    v_or_b32_dpp v49, v49, v49 quad_perm:[2,3,0,1] row_mask:0xf bank_mask:0xf
    v_or_b32_dpp v50, v50, v50 quad_perm:[2,3,0,1] row_mask:0xf bank_mask:0xf
    v_mfma_f32_16x16x32_bf16 v[76:79], v[64:67], v[24:27], 0
    s_waitcnt lgkmcnt(0)
    v_mfma_f32_16x16x32_bf16 v[72:75], v[68:71], v[20:23], v[72:75]
    v_mfma_f32_16x16x32_bf16 v[76:79], v[68:71], v[28:31], v[76:79]
    v_mul_f32 v54, v56, v48
    v_fmac_f32 v54, v58, v49
    v_fmac_f32 v54, v60, v50
    s_mov_b32 s62, 0
    s_nop 0
    v_add_f32_dpp v54, v54, v54 row_ror:8 row_mask:0xf bank_mask:0xf
    s_mov_b64 exec, 0xffff
    s_nop 0
    ds_write_b128 v6, v[74:77]
    s_mov_b64 exec, 1
    ds_inc_u32 v0, v98 offset:2080
    s_mov_b64 exec, -1
    v_mov_b32 v55, v54
    s_nop 1
    v_permlane32_swap_b32 v54, v55
    v_add_f32 v54, v54, v55
    v_mov_b32 v55, v54
    s_nop 1
    v_permlane16_swap_b32 v54, v55
    v_add_f32 v54, v54, v55
    v_rcp_f32 v52, v54
    s_cbranch_scc0 L_wo_nb0
    s_barrier
L_wo_nb0:
L_wo_s:
    ds_read_b32 v24, v100 offset:2080
    ds_read2st64_b32 v[16:17], v4 offset0:88 offset1:89
    ds_read2st64_b32 v[18:19], v4 offset0:90 offset1:91
    ds_read2st64_b32 v[20:21], v4 offset0:92 offset1:93
    ds_read2st64_b32 v[22:23], v4 offset0:94 offset1:95
    s_waitcnt lgkmcnt(4)
    v_cmp_ne_u32 vcc, 8, v24
    s_waitcnt lgkmcnt(0)
    v_pk_add_f32 v[16:17], v[16:17], v[18:19]
    v_pk_add_f32 v[20:21], v[20:21], v[22:23]
    v_pk_add_f32 v[16:17], v[16:17], v[20:21]
    v_add_f32 v16, v16, v17
    v_mul_f32 v16, v52, v16
    v_and_or_b32 v16, v16, v98, v99
    s_cbranch_vccnz L_wo_sr
L_wo_sok:
    buffer_store_dword v16, v4, s[44:47], s54 offen sc1
    buffer_store_dword v16, v4, s[44:47], s55 offen sc1
    s_waitcnt vmcnt(0)
    ds_write_b32 v100, v24 offset:2084
L_fin:
    s_endpgm
L_x3_r:
    s_cmp_eq_u32 s63, 4096
    s_cbranch_scc1 L_x3_x
    s_mov_b32 s63, 4096
    s_sub_u32 s40, s40, 393216
    s_sub_u32 s41, s41, 393216
    s_sub_u32 s42, s42, 393216
    s_barrier
    s_mov_b32 s43, 1
    s_branch L_x3_w
L_x3_x:
    s_waitcnt vmcnt(0)
    s_mov_b64 vcc, 0
    s_branch L_x3_ok
L_wo_sr:
    s_add_u32 s62, s62, 4096
    s_cbranch_scc0 L_wo_s
    s_branch L_wo_sok
.p2align 12
L_F2:
    s_load_dword s30, s[28:29], 0
    s_mov_b32 s44, s28
    s_mov_b32 s45, s29
    s_mov_b32 s46, 1441792
    s_mov_b32 s47, 0x20000
    s_mov_b32 s60, 0x05040100
    s_mov_b32 s61, 0x07060302
    s_lshl_b32 s52, s31, 8
    s_add_u32 s56, s52, 0x2400
    s_mov_b32 s59, 0x43e00000
    s_mov_b32 s58, 0x3f803f80
    v_mov_b32 v12, 0
    v_lshlrev_b32 v4, 2, v0
    ds_write_b32 v4, v12 offset:0
    v_add_u32 v6, s56, v6
    v_lshl_add_u32 v5, v5, 1, s52
    v_lshrrev_b32 v12, 4, v0
    v_lshlrev_b32 v12, 4, v12
    v_add_u32 v12, s56, v12
    v_and_b32 v13, 1, v0
    v_mov_b32 v14, 64
    v_cmp_eq_u32 vcc, 0, v13
    s_nop 1
    v_cndmask_b32 v8, v14, v12, vcc
    v_cmp_eq_u32 vcc, 1, v13
    s_nop 1
    v_cndmask_b32 v9, v14, v12, vcc
    s_waitcnt vmcnt(8)
    v_dot2_f32_bf16 v102, v96, s58, 0
    v_dot2_f32_bf16 v103, v96, v96, 0
    v_dot2_f32_bf16 v102, v97, s58, v102
    v_dot2_f32_bf16 v103, v97, v97, v103
    v_dot2_f32_bf16 v102, v98, s58, v102
    v_dot2_f32_bf16 v103, v98, v98, v103
    v_dot2_f32_bf16 v102, v99, s58, v102
    v_dot2_f32_bf16 v103, v99, v99, v103
    s_nop 1
    v_add_f32_dpp v102, v102, v102 row_ror:8 row_mask:0xf bank_mask:0xf
    v_add_f32_dpp v103, v103, v103 row_ror:8 row_mask:0xf bank_mask:0xf
    s_nop 0
    v_add_f32_dpp v102, v102, v102 row_ror:4 row_mask:0xf bank_mask:0xf
    v_add_f32_dpp v103, v103, v103 row_ror:4 row_mask:0xf bank_mask:0xf
    s_nop 0
    v_add_f32_dpp v102, v102, v102 row_ror:2 row_mask:0xf bank_mask:0xf
    v_add_f32_dpp v103, v103, v103 row_ror:2 row_mask:0xf bank_mask:0xf
    s_nop 0
    v_add_f32_dpp v102, v102, v102 row_ror:1 row_mask:0xf bank_mask:0xf
    v_add_f32_dpp v103, v103, v103 row_ror:1 row_mask:0xf bank_mask:0xf
    v_mov_b32 v104, v102
    s_nop 1
    v_permlane32_swap_b32 v102, v104
    v_add_f32 v102, v102, v104
    v_mov_b32 v104, v102
    s_nop 1
    v_permlane16_swap_b32 v102, v104
    v_add_f32 v102, v102, v104
    v_mov_b32 v104, v103
    s_nop 1
    v_permlane32_swap_b32 v103, v104
    v_add_f32 v103, v103, v104
    v_mov_b32 v104, v103
    s_nop 1
    v_permlane16_swap_b32 v103, v104
    v_add_f32 v103, v103, v104
    v_lshlrev_b32 v96, 16, v100
    v_mul_f32 v104, v102, v102
    v_fma_f32 v105, v102, v102, -v104
    v_fma_f32 v104, v103, s59, -v104
    v_sub_f32 v104, v104, v105
    v_mul_f32 v104, 0x36a72f05, v104
    v_max_f32 v104, 0, v104
    v_cvt_pk_bf16_f32 v104, 0, v104
    v_add_f32 v104, 0x3727c5ac, v104
    v_cvt_pk_bf16_f32 v104, 0, v104
    v_sqrt_f32 v104, v104
    v_mul_f32 v105, 0x3b124925, v102
    v_cvt_pk_bf16_f32 v104, 0, v104
    v_cvt_pk_bf16_f32 v105, 0, v105
    v_rcp_f32 v106, v104
    v_sub_f32 v105, v96, v105
    v_cvt_pk_bf16_f32 v105, 0, v105
    v_mul_f32 v107, v105, v106
    v_fma_f32 v104, -v107, v104, v105
    v_fmac_f32 v107, v104, v106
    v_cvt_pk_bf16_f32 v100, 0, v107
    s_lshl_b32 s52, s32, 11
    s_lshl_b32 s53, s33, 8
    s_add_u32 s52, s52, s53
    s_add_u32 s53, s52, 32768
    s_add_u32 s52, s52, 16384
    s_waitcnt lgkmcnt(0)
    s_add_u32 s30, s30, 1
    s_and_b32 s34, s30, 0x7f
    s_xor_b32 s35, s34, 0x5a
    s_lshl_b32 s3, s35, 8
    s_or_b32 s3, s3, s34
    s_waitcnt vmcnt(4)
    v_pk_mov_b32 v[104:105], v[34:35], v[34:35] op_sel:[0,1]
    v_pk_mov_b32 v[106:107], v[38:39], v[38:39] op_sel:[0,1]
    v_mov_b32_dpp v34, v32 row_ror:8 row_mask:0xf bank_mask:0x3
    v_mov_b32_dpp v35, v33 row_ror:8 row_mask:0xf bank_mask:0x3
    v_mov_b32_dpp v38, v36 row_ror:8 row_mask:0xf bank_mask:0x3
    v_mov_b32_dpp v39, v37 row_ror:8 row_mask:0xf bank_mask:0x3
    v_mov_b32_dpp v32, v104 row_ror:8 row_mask:0xf bank_mask:0xc
    v_mov_b32_dpp v33, v105 row_ror:8 row_mask:0xf bank_mask:0xc
    v_mov_b32_dpp v36, v106 row_ror:8 row_mask:0xf bank_mask:0xc
    v_mov_b32_dpp v37, v107 row_ror:8 row_mask:0xf bank_mask:0xc
    v_pk_mov_b32 v[104:105], v[42:43], v[42:43] op_sel:[0,1]
    v_pk_mov_b32 v[106:107], v[46:47], v[46:47] op_sel:[0,1]
    v_mov_b32_dpp v42, v40 row_ror:8 row_mask:0xf bank_mask:0x3
    v_mov_b32_dpp v43, v41 row_ror:8 row_mask:0xf bank_mask:0x3
    v_mov_b32_dpp v46, v44 row_ror:8 row_mask:0xf bank_mask:0x3
    v_mov_b32_dpp v47, v45 row_ror:8 row_mask:0xf bank_mask:0x3
    v_mov_b32_dpp v40, v104 row_ror:8 row_mask:0xf bank_mask:0xc
    v_mov_b32_dpp v41, v105 row_ror:8 row_mask:0xf bank_mask:0xc
    v_mov_b32_dpp v44, v106 row_ror:8 row_mask:0xf bank_mask:0xc
    v_mov_b32_dpp v45, v107 row_ror:8 row_mask:0xf bank_mask:0xc
    v_perm_b32 v64, v34, v32, s60
    v_perm_b32 v65, v38, v36, s60
    v_perm_b32 v66, v42, v40, s60
    v_perm_b32 v67, v46, v44, s60
    v_perm_b32 v68, v34, v32, s61
    v_perm_b32 v69, v38, v36, s61
    v_perm_b32 v70, v42, v40, s61
    v_perm_b32 v71, v46, v44, s61
    v_perm_b32 v72, v35, v33, s60
    v_perm_b32 v73, v39, v37, s60
    v_perm_b32 v74, v43, v41, s60
    v_perm_b32 v75, v47, v45, s60
    v_perm_b32 v76, v35, v33, s61
    v_perm_b32 v77, v39, v37, s61
    v_perm_b32 v78, v43, v41, s61
    v_perm_b32 v79, v47, v45, s61
    s_mov_b32 s49, 98304
    s_add_u32 s50, s31, 0
    s_lshr_b32 s63, s50, 3
    s_lshl_b32 s63, s63, 13
    s_lshl_b32 s50, s50, 10
    s_add_u32 s50, s50, s63
    s_add_u32 s50, s50, s49
    s_add_u32 s51, s31, 7
    s_lshr_b32 s63, s51, 3
    s_lshl_b32 s63, s63, 13
    s_lshl_b32 s51, s51, 10
    s_add_u32 s51, s51, s63
    s_add_u32 s51, s51, s49
    s_waitcnt vmcnt(0)
    v_pk_mov_b32 v[104:105], v[50:51], v[50:51] op_sel:[0,1]
    v_pk_mov_b32 v[106:107], v[54:55], v[54:55] op_sel:[0,1]
    v_mov_b32_dpp v50, v48 row_ror:8 row_mask:0xf bank_mask:0x3
    v_mov_b32_dpp v51, v49 row_ror:8 row_mask:0xf bank_mask:0x3
    v_mov_b32_dpp v54, v52 row_ror:8 row_mask:0xf bank_mask:0x3
    v_mov_b32_dpp v55, v53 row_ror:8 row_mask:0xf bank_mask:0x3
    v_mov_b32_dpp v48, v104 row_ror:8 row_mask:0xf bank_mask:0xc
    v_mov_b32_dpp v49, v105 row_ror:8 row_mask:0xf bank_mask:0xc
    v_mov_b32_dpp v52, v106 row_ror:8 row_mask:0xf bank_mask:0xc
    v_mov_b32_dpp v53, v107 row_ror:8 row_mask:0xf bank_mask:0xc
    v_pk_mov_b32 v[104:105], v[58:59], v[58:59] op_sel:[0,1]
    v_pk_mov_b32 v[106:107], v[62:63], v[62:63] op_sel:[0,1]
    v_mov_b32_dpp v58, v56 row_ror:8 row_mask:0xf bank_mask:0x3
    v_mov_b32_dpp v59, v57 row_ror:8 row_mask:0xf bank_mask:0x3
    v_mov_b32_dpp v62, v60 row_ror:8 row_mask:0xf bank_mask:0x3
    v_mov_b32_dpp v63, v61 row_ror:8 row_mask:0xf bank_mask:0x3
    v_mov_b32_dpp v56, v104 row_ror:8 row_mask:0xf bank_mask:0xc
    v_mov_b32_dpp v57, v105 row_ror:8 row_mask:0xf bank_mask:0xc
    v_mov_b32_dpp v60, v106 row_ror:8 row_mask:0xf bank_mask:0xc
    v_mov_b32_dpp v61, v107 row_ror:8 row_mask:0xf bank_mask:0xc
    v_perm_b32 v80, v50, v48, s60
    v_perm_b32 v81, v54, v52, s60
    v_perm_b32 v82, v58, v56, s60
    v_perm_b32 v83, v62, v60, s60
    v_perm_b32 v84, v50, v48, s61
    v_perm_b32 v85, v54, v52, s61
    v_perm_b32 v86, v58, v56, s61
    v_perm_b32 v87, v62, v60, s61
    v_perm_b32 v88, v51, v49, s60
    v_perm_b32 v89, v55, v53, s60
    v_perm_b32 v90, v59, v57, s60
    v_perm_b32 v91, v63, v61, s60
    v_perm_b32 v92, v51, v49, s61
    v_perm_b32 v93, v55, v53, s61
    v_perm_b32 v94, v59, v57, s61
    v_perm_b32 v95, v63, v61, s61
    s_add_u32 s8, s31, 14
    s_lshr_b32 s63, s8, 3
    s_lshl_b32 s63, s63, 13
    s_lshl_b32 s8, s8, 10
    s_add_u32 s8, s8, s63
    s_add_u32 s8, s8, s49
    s_add_u32 s9, s31, 21
    s_lshr_b32 s63, s9, 3
    s_lshl_b32 s63, s63, 13
    s_lshl_b32 s9, s9, 10
    s_add_u32 s9, s9, s63
    s_add_u32 s9, s9, s49
    s_add_u32 s10, s31, 28
    s_lshr_b32 s63, s10, 3
    s_lshl_b32 s63, s63, 13
    s_lshl_b32 s10, s10, 10
    s_add_u32 s10, s10, s63
    s_add_u32 s10, s10, s49
    s_add_u32 s11, s31, 35
    s_lshr_b32 s63, s11, 3
    s_lshl_b32 s63, s63, 13
    s_lshl_b32 s11, s11, 10
    s_add_u32 s11, s11, s63
    s_add_u32 s11, s11, s49
    v_mov_b32 v42, 0
    ds_read_b32 v43, v42 offset:588
    s_and_b32 s4, s34, 3
    s_and_b32 s5, s35, 3
    s_mov_b32 s62, 0
    s_waitcnt lgkmcnt(0)
L_q_x1:
    v_add_u32 v41, v7, v43
    buffer_load_dwordx4 v[32:35], v41, s[44:47], s50 offen sc1
    buffer_load_dwordx4 v[36:39], v41, s[44:47], s51 offen sc1
    ds_read_b32 v43, v42 offset:588
L_q_x1_w:
    s_waitcnt vmcnt(0) lgkmcnt(0)
    v_xor_b32 v32, s4, v32
    v_xor_b32 v33, s5, v33
    v_xor_b32 v34, s4, v34
    v_xor_b32 v35, s5, v35
    v_xor_b32 v36, s4, v36
    v_xor_b32 v37, s5, v37
    v_xor_b32 v38, s4, v38
    v_xor_b32 v39, s5, v39
    v_or_b32 v40, v32, v33
    v_or3_b32 v40, v40, v34, v35
    v_or3_b32 v40, v40, v36, v37
    v_or3_b32 v40, v40, v38, v39
    v_and_b32 v40, 3, v40
    v_cmp_ne_u32 vcc, 0, v40
    s_cbranch_vccz L_q_x1_ok
    s_add_u32 s62, s62, 4096
    s_cbranch_scc0 L_q_x1
L_q_x1_ok:
    v_permlane32_swap_b32 v36, v38
    v_permlane32_swap_b32 v37, v39
    v_pk_add_f32 v[36:37], v[36:37], v[38:39]
    s_nop 1
    v_permlane16_swap_b32 v36, v37
    v_add_f32 v36, v36, v37
    v_permlane32_swap_b32 v32, v34
    v_permlane32_swap_b32 v33, v35
    v_pk_add_f32 v[32:33], v[32:33], v[34:35]
    s_nop 1
    v_permlane16_swap_b32 v32, v33
    v_add_f32 v32, v32, v33
    v_cvt_pk_bf16_f32 v36, 0, v36
    v_cvt_pk_bf16_f32 v32, 0, v32
    v_add_f32 v36, 1.0, v36
    v_cvt_pk_bf16_f32 v36, 0, v36
    v_mul_f32 v36, v100, v36
    v_cvt_pk_bf16_f32 v36, 0, v36
    v_add_f32 v36, v36, v32
    v_cvt_pk_bf16_f32 v36, 0, v36
    ds_write_b16_d16_hi v6, v36
    ds_read_b128 v[32:35], v8 offset:0
    ds_read_b128 v[36:39], v9 offset:0
    ds_read_b128 v[40:43], v8 offset:64
    ds_read_b128 v[44:47], v9 offset:64
    s_waitcnt lgkmcnt(3)
    v_mfma_f32_16x16x32_bf16 v[48:51], v[32:35], v[64:67], 0
    v_mfma_f32_16x16x32_bf16 v[52:55], v[32:35], v[72:75], 0
    s_waitcnt lgkmcnt(2)
    v_mfma_f32_16x16x32_bf16 v[48:51], v[36:39], v[68:71], v[48:51]
    v_mfma_f32_16x16x32_bf16 v[52:55], v[36:39], v[76:79], v[52:55]
    s_waitcnt lgkmcnt(1)
    v_mfma_f32_16x16x32_bf16 v[48:51], v[40:43], v[80:83], v[48:51]
    v_mfma_f32_16x16x32_bf16 v[52:55], v[40:43], v[88:91], v[52:55]
    s_waitcnt lgkmcnt(0)
    v_mfma_f32_16x16x32_bf16 v[48:51], v[44:47], v[84:87], v[48:51]
    v_mfma_f32_16x16x32_bf16 v[52:55], v[44:47], v[92:95], v[52:55]
    v_mov_b32 v24, 1
    s_mov_b32 s62, 0
    s_mov_b64 exec, 0xffff
    s_cmp_eq_u32 s31, 0
    s_nop 3
    ds_write_b128 v5, v[50:53] offset:4096
    s_mov_b64 exec, 1
    ds_add_u32 v0, v24 offset:580
    s_mov_b64 exec, -1
    s_cbranch_scc0 L_q_done
    v_mov_b32 v25, 0
L_q_s:
    ds_read_b32 v24, v25 offset:580
    ds_read2st64_b32 v[16:17], v4 offset0:16 offset1:17
    ds_read2st64_b32 v[18:19], v4 offset0:18 offset1:19
    ds_read2st64_b32 v[20:21], v4 offset0:20 offset1:21
    ds_read_b32 v22, v4 offset:5632
    v_mov_b32 v23, 0
    s_waitcnt lgkmcnt(0)
    v_cmp_ne_u32 vcc, 8, v24
    v_pk_add_f32 v[16:17], v[16:17], v[18:19]
    v_pk_add_f32 v[20:21], v[20:21], v[22:23]
    v_pk_add_f32 v[16:17], v[16:17], v[20:21]
    v_add_f32 v16, v16, v17
    v_cvt_pk_bf16_f32 v16, 0, v16
    v_or_b32 v16, s3, v16
    s_cbranch_vccnz L_q_sr
L_q_sok:
    buffer_store_dword v16, v4, s[44:47], s53 offen
    buffer_store_dword v16, v4, s[44:47], s52 offen sc1
    ds_write_b32 v25, v24 offset:592
    s_cmp_eq_u32 s33, 7
    s_cbranch_scc0 L_q_done
    s_getpc_b64 s[4:5]
L_pc2:
    s_sub_u32 s4, s4, L_pc2-L_pc
    s_subb_u32 s5, s5, 0
    v_lshlrev_b32 v102, 7, v0
    v_add_u32 v103, 0x2000, v102
    v_min_u32 v103, L_code_end-L_pc-4, v103
    global_load_dword v127, v102, s[4:5] sc1
    global_load_dword v127, v103, s[4:5] sc1
L_q_done:
    s_cmp_lt_u32 s32, 4
    s_cselect_b32 s50, 6, 8
    s_cselect_b32 s51, 0, 8
    s_cmp_lt_u32 s33, s50
    s_cbranch_scc0 L_fin2
    s_mul_i32 s50, s50, s32
    s_add_u32 s50, s50, s33
    s_sub_u32 s50, s50, s51
    s_mov_b32 s36, s16
    s_mov_b32 s37, s17
    s_mov_b32 s38, 1605632
    s_mov_b32 s40, s18
    s_mov_b32 s41, s19
    s_mov_b32 s42, 1605632
    s_mul_i32 s52, s31, 229376
    s_lshl_b32 s53, s50, 6
    s_add_u32 s52, s52, s53
    s_mul_i32 s54, s50, 28672
    s_lshl_b32 s55, s31, 7
    s_add_u32 s54, s54, s55
    s_add_u32 s55, s54, 3584
    v_and_b32 v4, 15, v0
    v_mul_u32_u24 v2, 28672, v3
    v_lshl_add_u32 v2, v4, 2, v2
    v_lshrrev_b32 v102, 4, v0
    v_mul_u32_u24 v1, 7168, v102
    v_bfe_u32 v102, v0, 3, 1
    v_mul_u32_u24 v102, 896, v102
    v_add_u32 v1, v1, v102
    v_and_b32 v102, 7, v0
    v_lshl_add_u32 v1, v102, 4, v1
    v_mov_b32 v102, 0
    s_mov_b32 s62, 0
L_f_q:
    s_sleep 1
    ds_read_b32 v103, v102 offset:592
    s_waitcnt lgkmcnt(0)
    v_cmp_gt_u32 vcc, 1, v103
    s_cbranch_vccz L_f_qok
    s_add_u32 s62, s62, 4096
    s_cbranch_scc0 L_f_q
L_f_qok:
    v_mov_b32 v122, 0
    ds_read_b32 v123, v122 offset:588
    s_and_b32 s4, s34, 3
    s_and_b32 s5, s35, 3
    s_mov_b32 s62, 0
    s_waitcnt lgkmcnt(0)
L_f_mx:
    v_add_u32 v121, v7, v123
    buffer_load_dwordx4 v[104:107], v121, s[44:47], s8 offen sc1
    buffer_load_dwordx4 v[108:111], v121, s[44:47], s9 offen sc1
    buffer_load_dwordx4 v[112:115], v121, s[44:47], s10 offen sc1
    buffer_load_dwordx4 v[116:119], v121, s[44:47], s11 offen sc1
    ds_read_b32 v123, v122 offset:588
L_f_mx_w:
    s_waitcnt vmcnt(0) lgkmcnt(0)
    v_xor_b32 v104, s4, v104
    v_xor_b32 v105, s5, v105
    v_xor_b32 v106, s4, v106
    v_xor_b32 v107, s5, v107
    v_xor_b32 v108, s4, v108
    v_xor_b32 v109, s5, v109
    v_xor_b32 v110, s4, v110
    v_xor_b32 v111, s5, v111
    v_xor_b32 v112, s4, v112
    v_xor_b32 v113, s5, v113
    v_xor_b32 v114, s4, v114
    v_xor_b32 v115, s5, v115
    v_xor_b32 v116, s4, v116
    v_xor_b32 v117, s5, v117
    v_xor_b32 v118, s4, v118
    v_xor_b32 v119, s5, v119
    v_or_b32 v120, v104, v105
    v_or3_b32 v120, v120, v106, v107
    v_or3_b32 v120, v120, v108, v109
    v_or3_b32 v120, v120, v110, v111
    v_or3_b32 v120, v120, v112, v113
    v_or3_b32 v120, v120, v114, v115
    v_or3_b32 v120, v120, v116, v117
    v_or3_b32 v120, v120, v118, v119
    v_and_b32 v120, 3, v120
    v_cmp_ne_u32 vcc, 0, v120
    s_cbranch_vccz L_f_mx_ok
    s_add_u32 s62, s62, 4096
    s_cbranch_scc0 L_f_mx
L_f_mx_ok:
    v_permlane32_swap_b32 v104, v106
    v_permlane32_swap_b32 v105, v107
    v_pk_add_f32 v[104:105], v[104:105], v[106:107]
    s_nop 1
    v_permlane16_swap_b32 v104, v105
    v_add_f32 v104, v104, v105
    v_permlane32_swap_b32 v108, v110
    v_permlane32_swap_b32 v109, v111
    v_pk_add_f32 v[108:109], v[108:109], v[110:111]
    s_nop 1
    v_permlane16_swap_b32 v108, v109
    v_add_f32 v108, v108, v109
    v_permlane32_swap_b32 v112, v114
    v_permlane32_swap_b32 v113, v115
    v_pk_add_f32 v[112:113], v[112:113], v[114:115]
    s_nop 1
    v_permlane16_swap_b32 v112, v113
    v_add_f32 v112, v112, v113
    v_permlane32_swap_b32 v116, v118
    v_permlane32_swap_b32 v117, v119
    v_pk_add_f32 v[116:117], v[116:117], v[118:119]
    s_nop 1
    v_permlane16_swap_b32 v116, v117
    v_add_f32 v116, v116, v117
    v_cvt_pk_bf16_f32 v102, 0, v104
    v_cvt_pk_bf16_f32 v98, 0, v108
    v_cvt_pk_bf16_f32 v100, 0, v112
    v_cvt_pk_bf16_f32 v116, 0, v116
    v_add_f32 v100, 1.0, v100
    s_lshl_b32 s13, s31, 8
    v_lshl_add_u32 v103, v0, 2, s13
    v_cvt_pk_bf16_f32 v100, 0, v100
    ds_write_b32 v103, v116 offset:14336
    ds_write_b16_d16_hi v6, v100
    ds_write_b16_d16_hi v6, v98 offset:128
    s_branch L_f_gp
L_f_gb:
    buffer_load_dword v32, v2, s[36:39], s52 offen offset:0
    buffer_load_dword v33, v2, s[36:39], s52 offen offset:3584
    s_add_u32 s52, s52, 7168
    buffer_load_dword v34, v2, s[36:39], s52 offen offset:0
    buffer_load_dword v35, v2, s[36:39], s52 offen offset:3584
    s_add_u32 s52, s52, 7168
    buffer_load_dword v36, v2, s[36:39], s52 offen offset:0
    buffer_load_dword v37, v2, s[36:39], s52 offen offset:3584
    s_add_u32 s52, s52, 7168
    buffer_load_dword v38, v2, s[36:39], s52 offen offset:0
    buffer_load_dword v39, v2, s[36:39], s52 offen offset:3584
    s_add_u32 s52, s52, 93184
    buffer_load_dword v40, v2, s[36:39], s52 offen offset:0
    buffer_load_dword v41, v2, s[36:39], s52 offen offset:3584
    s_add_u32 s52, s52, 7168
    buffer_load_dword v42, v2, s[36:39], s52 offen offset:0
    buffer_load_dword v43, v2, s[36:39], s52 offen offset:3584
    s_add_u32 s52, s52, 7168
    buffer_load_dword v44, v2, s[36:39], s52 offen offset:0
    buffer_load_dword v45, v2, s[36:39], s52 offen offset:3584
    s_add_u32 s52, s52, 7168
    buffer_load_dword v46, v2, s[36:39], s52 offen offset:0
    buffer_load_dword v47, v2, s[36:39], s52 offen offset:3584
    s_add_u32 s52, s52, 7168
    buffer_load_dwordx4 v[48:51], v1, s[40:43], s54 offen offset:0 nt
    buffer_load_dwordx4 v[52:55], v1, s[40:43], s54 offen offset:1792 nt
    buffer_load_dwordx4 v[56:59], v1, s[40:43], s55 offen offset:0 nt
    buffer_load_dwordx4 v[60:63], v1, s[40:43], s55 offen offset:1792 nt
    v_lshrrev_b32 v104, 4, v0
    v_lshlrev_b32 v104, 4, v104
    v_add_u32 v104, 8448, v104
    v_and_b32 v105, 1, v0
    v_mov_b32 v106, 64
    v_cmp_eq_u32 vcc, 0, v105
    s_nop 1
    v_cndmask_b32 v10, v106, v104, vcc
    v_cmp_eq_u32 vcc, 1, v105
    s_nop 1
    v_cndmask_b32 v11, v106, v104, vcc
    v_bfe_u32 v5, v0, 0, 1
    v_mul_u32_u24 v5, 0x5a, v5
    v_xor_b32 v5, s34, v5
    v_mov_b32 v104, 0
    ds_read_b32 v104, v104 offset:588
    s_waitcnt lgkmcnt(0)
    v_readfirstlane_b32 s48, v104
    s_lshr_b32 s12, s50, 2
    s_lshl_b32 s12, s12, 13
    s_lshl_b32 s14, s50, 11
    s_add_u32 s12, s12, s14
    s_add_u32 s12, s12, s13
    s_add_u32 s12, s12, 262144
    v_and_b32 v7, 1, v3
    v_lshlrev_b32 v7, 13, v7
    v_lshl_add_u32 v7, v4, 4, v7
    v_and_b32 v8, 1, v0
    v_lshlrev_b32 v8, 7, v8
    v_lshl_add_u32 v8, v3, 4, v8
    v_add_u32 v8, s56, v8
    v_lshlrev_b32 v2, 11, v3
    v_lshl_add_u32 v2, v4, 4, v2
    s_add_u32 s52, s13, 16384
    v_lshl_add_u32 v9, v0, 3, s52
    s_lshl_b32 s52, s31, 7
    s_add_u32 s52, s52, 6144
    v_lshl_add_u32 v4, v0, 3, s52
    s_add_u32 s40, s13, s48
    s_add_u32 s40, s40, 196608
    s_add_u32 s41, s40, 16384
    s_add_u32 s42, s40, 32768
    s_add_u32 s43, s40, 49152
    s_lshl_b32 s52, s31, 3
    s_add_u32 s52, s52, 8192
    v_lshrrev_b32 v1, 5, v0
    v_lshl_add_u32 v3, v1, 2, s52
    s_mov_b32 s57, 0xffffff00
    s_mov_b32 s16, 0x10000
    s_mov_b32 s17, 0x10000
    ds_read_b128 v[80:83], v8
    ds_read_b128 v[84:87], v8 offset:64
    v_mov_b32 v12, 0
    v_mov_b32 v13, 1
    v_mov_b32 v120, 1
    s_waitcnt vmcnt(4) lgkmcnt(0)
    buffer_load_dwordx4 v[104:107], v2, s[44:47], s40 offen sc1
    buffer_load_dwordx4 v[108:111], v2, s[44:47], s41 offen sc1
    buffer_load_dwordx4 v[112:115], v2, s[44:47], s42 offen sc1
    buffer_load_dwordx4 v[116:119], v2, s[44:47], s43 offen sc1
    v_perm_b32 v16, v33, v32, s60
    v_perm_b32 v17, v35, v34, s60
    v_perm_b32 v18, v37, v36, s60
    v_perm_b32 v19, v39, v38, s60
    v_perm_b32 v20, v33, v32, s61
    v_perm_b32 v21, v35, v34, s61
    v_perm_b32 v22, v37, v36, s61
    v_perm_b32 v23, v39, v38, s61
    v_perm_b32 v24, v41, v40, s60
    v_perm_b32 v25, v43, v42, s60
    v_perm_b32 v26, v45, v44, s60
    v_perm_b32 v27, v47, v46, s60
    v_perm_b32 v28, v41, v40, s61
    v_perm_b32 v29, v43, v42, s61
    v_perm_b32 v30, v45, v44, s61
    v_perm_b32 v31, v47, v46, s61
    v_mfma_f32_16x16x32_bf16 v[88:91], v[80:83], v[16:19], 0
    v_mfma_f32_16x16x32_bf16 v[92:95], v[80:83], v[20:23], 0
    v_mfma_f32_16x16x32_bf16 v[88:91], v[84:87], v[24:27], v[88:91]
    v_mfma_f32_16x16x32_bf16 v[92:95], v[84:87], v[28:31], v[92:95]
    s_mov_b64 exec, 0xffff
    s_nop 6
    ds_write2_b32 v9, v88, v92 offset0:0 offset1:1
    ds_write2_b32 v9, v89, v93 offset0:32 offset1:33
    s_mov_b64 exec, 1
    ds_add_u32 v0, v120 offset:576
    s_mov_b64 exec, -1
    s_waitcnt vmcnt(4)
    v_pk_mov_b32 v[124:125], v[50:51], v[50:51] op_sel:[0,1]
    v_pk_mov_b32 v[126:127], v[54:55], v[54:55] op_sel:[0,1]
    v_mov_b32_dpp v50, v48 row_ror:8 row_mask:0xf bank_mask:0x3
    v_mov_b32_dpp v51, v49 row_ror:8 row_mask:0xf bank_mask:0x3
    v_mov_b32_dpp v54, v52 row_ror:8 row_mask:0xf bank_mask:0x3
    v_mov_b32_dpp v55, v53 row_ror:8 row_mask:0xf bank_mask:0x3
    v_mov_b32_dpp v48, v124 row_ror:8 row_mask:0xf bank_mask:0xc
    v_mov_b32_dpp v49, v125 row_ror:8 row_mask:0xf bank_mask:0xc
    v_mov_b32_dpp v52, v126 row_ror:8 row_mask:0xf bank_mask:0xc
    v_mov_b32_dpp v53, v127 row_ror:8 row_mask:0xf bank_mask:0xc
    v_pk_mov_b32 v[124:125], v[58:59], v[58:59] op_sel:[0,1]
    v_pk_mov_b32 v[126:127], v[62:63], v[62:63] op_sel:[0,1]
    v_mov_b32_dpp v58, v56 row_ror:8 row_mask:0xf bank_mask:0x3
    v_mov_b32_dpp v59, v57 row_ror:8 row_mask:0xf bank_mask:0x3
    v_mov_b32_dpp v62, v60 row_ror:8 row_mask:0xf bank_mask:0x3
    v_mov_b32_dpp v63, v61 row_ror:8 row_mask:0xf bank_mask:0x3
    v_mov_b32_dpp v56, v124 row_ror:8 row_mask:0xf bank_mask:0xc
    v_mov_b32_dpp v57, v125 row_ror:8 row_mask:0xf bank_mask:0xc
    v_mov_b32_dpp v60, v126 row_ror:8 row_mask:0xf bank_mask:0xc
    v_mov_b32_dpp v61, v127 row_ror:8 row_mask:0xf bank_mask:0xc
    v_perm_b32 v64, v50, v48, s60
    v_perm_b32 v65, v54, v52, s60
    v_perm_b32 v66, v58, v56, s60
    v_perm_b32 v67, v62, v60, s60
    v_perm_b32 v68, v50, v48, s61
    v_perm_b32 v69, v54, v52, s61
    v_perm_b32 v70, v58, v56, s61
    v_perm_b32 v71, v62, v60, s61
    v_perm_b32 v72, v51, v49, s60
    v_perm_b32 v73, v55, v53, s60
    v_perm_b32 v74, v59, v57, s60
    v_perm_b32 v75, v63, v61, s60
    v_perm_b32 v76, v51, v49, s61
    v_perm_b32 v77, v55, v53, s61
    v_perm_b32 v78, v59, v57, s61
    v_perm_b32 v79, v63, v61, s61
    s_setprio 2
    s_mov_b32 s62, 0
    s_branch L_x4_w
.p2align 12
L_f_gp:
    v_mov_b32 v104, 0
    s_mov_b32 s62, 0
L_f_g:
    s_sleep 1
    ds_read_b32 v105, v104 offset:584
    s_waitcnt lgkmcnt(0)
    v_cmp_gt_u32 vcc, 1, v105
    s_cbranch_vccz L_f_gok
    s_add_u32 s62, s62, 4096
    s_cbranch_scc0 L_f_g
L_f_gok:
    s_branch L_f_gb
.p2align 6
    s_nop 0
    s_nop 0
    s_nop 0
    s_nop 0
L_x4:
    s_wqm_b64 exec, s[4:5]
    s_cbranch_scc0 L_x4_z0
    buffer_load_dwordx4 v[104:107], v2, s[44:47], s40 offen sc1
L_x4_z0:
    s_wqm_b64 exec, s[6:7]
    s_cbranch_scc0 L_x4_z1
    buffer_load_dwordx4 v[108:111], v2, s[44:47], s41 offen sc1
L_x4_z1:
    s_wqm_b64 exec, s[8:9]
    s_cbranch_scc0 L_x4_z2
    buffer_load_dwordx4 v[112:115], v2, s[44:47], s42 offen sc1
L_x4_z2:
    s_wqm_b64 exec, s[10:11]
    s_cbranch_scc0 L_x4_z3
    buffer_load_dwordx4 v[116:119], v2, s[44:47], s43 offen sc1
L_x4_z3:
    s_mov_b64 exec, -1
    s_add_u32 s62, s62, 4096
    s_cbranch_scc1 L_x4_r
L_x4_w:
    s_waitcnt vmcnt(0)
    v_cmp_ne_u32_sdwa s[4:5], v104, v5 src0_sel:BYTE_0 src1_sel:DWORD
    v_cmp_ne_u32_sdwa s[6:7], v108, v5 src0_sel:BYTE_0 src1_sel:DWORD
    v_cmp_ne_u32_sdwa s[8:9], v112, v5 src0_sel:BYTE_0 src1_sel:DWORD
    v_cmp_ne_u32_sdwa s[10:11], v116, v5 src0_sel:BYTE_0 src1_sel:DWORD
    v_pk_add_f32 v[122:123], v[106:107], v[110:111]
    v_pk_add_f32 v[120:121], v[114:115], v[118:119]
    v_pk_add_f32 v[122:123], v[122:123], v[120:121]
    s_or_b64 vcc, s[4:5], s[6:7]
    s_or_b64 vcc, vcc, s[8:9]
    s_or_b64 vcc, vcc, s[10:11]
    s_cbranch_scc1 L_x4
L_x4_ok:
    v_xor_b32 v104, v104, v5
    v_xor_b32 v108, v108, v5
    v_xor_b32 v112, v112, v5
    v_xor_b32 v116, v116, v5
    v_pk_add_f32 v[104:105], v[104:105], v[108:109]
    v_pk_add_f32 v[112:113], v[112:113], v[116:117]
    v_pk_add_f32 v[120:121], v[104:105], v[112:113]
    s_nop 1
    v_permlane32_swap_b32 v120, v122
    v_permlane32_swap_b32 v121, v123
    v_pk_add_f32 v[120:121], v[120:121], v[122:123]
    s_nop 1
    v_permlane16_swap_b32 v120, v121
    v_add_f32 v120, v120, v121
    v_cvt_pk_bf16_f32 v120, 0, v120
    v_mul_f32 v120, v102, v120
    v_cvt_pk_bf16_f32 v120, 0, v120
    v_add_f32 v120, v96, v120
    v_cvt_pk_bf16_f32 v121, 0, v120
    v_mul_f32 v123, v121, v100
    v_mul_f32 v122, v121, v121
    v_cvt_pk_bf16_f32 v124, 0, v123
    v_sub_f32 v124, v123, v124
    v_cvt_pk_bf16_f32 v123, v124, v123
    ds_write_b16_d16_hi v6, v123
    ds_write_b16 v6, v123 offset:128
    ds_read_b128 v[80:83], v8
    ds_read_b128 v[84:87], v8 offset:64
    ds_write_b32 v103, v121 offset:12288
    v_permlane32_swap_b32 v121, v122
    v_add_f32 v121, v121, v122
    s_nop 1
    v_add_f32_dpp v121, v121, v121 row_ror:8 row_mask:0xf bank_mask:0xf
    s_nop 1
    v_add_f32_dpp v121, v121, v121 row_ror:4 row_mask:0xf bank_mask:0xf
    s_nop 1
    v_add_f32_dpp v121, v121, v121 row_ror:2 row_mask:0xf bank_mask:0xf
    s_waitcnt lgkmcnt(2)
    v_mfma_f32_16x16x32_bf16 v[88:91], v[80:83], v[16:19], 0
    v_mfma_f32_16x16x32_bf16 v[92:95], v[80:83], v[20:23], 0
    v_add_f32_dpp v121, v121, v121 row_ror:1 row_mask:0xf bank_mask:0xf
    s_waitcnt lgkmcnt(1)
    v_mfma_f32_16x16x32_bf16 v[88:91], v[84:87], v[24:27], v[88:91]
    v_mfma_f32_16x16x32_bf16 v[92:95], v[84:87], v[28:31], v[92:95]
    v_add_f32_dpp v121, v121, v121 row_bcast:15 row_mask:0xa bank_mask:0xf
    s_mov_b64 exec, s[16:17]
    ds_write_b32 v3, v121
    s_mov_b64 exec, 0xffff
    s_nop 2
    v_add_f32 v88, v88, v89
    v_add_f32 v92, v92, v93
    ds_write2_b32 v4, v88, v92 offset0:0 offset1:1
    s_mov_b64 exec, 1
    ds_add_u32 v12, v13 offset:600
    s_barrier
    s_mov_b64 exec, -1
    s_mov_b32 s62, 0
    s_barrier
L_f_h1:
    ds_read_b32 v14, v12 offset:604
    ds_read_b128 v[80:83], v10
    ds_read_b128 v[84:87], v11
    s_waitcnt lgkmcnt(1)
    v_mfma_f32_16x16x32_bf16 v[32:35], v[80:83], v[64:67], 0
    v_cmp_eq_u32 vcc, 0, v14
    v_mfma_f32_16x16x32_bf16 v[36:39], v[80:83], v[72:75], 0
    s_waitcnt lgkmcnt(0)
    v_mfma_f32_16x16x32_bf16 v[32:35], v[84:87], v[68:71], v[32:35]
    v_mfma_f32_16x16x32_bf16 v[36:39], v[84:87], v[76:79], v[36:39]
    s_cbranch_vccnz L_f_h1r
L_f_h1ok:
    s_mov_b32 exec_hi, 0
    s_nop 4
    v_and_or_b32 v34, v34, s57, v5
    buffer_store_dwordx4 v[34:37], v7, s[44:47], s12 offen sc1
    s_barrier
L_fin2:
    s_endpgm
L_q_sr:
    s_add_u32 s62, s62, 4096
    s_cbranch_scc0 L_q_s
    s_branch L_q_sok
L_x4_r:
    s_waitcnt vmcnt(0)
    s_mov_b64 vcc, 0
    s_branch L_x4_ok
L_f_h1r:
    s_add_u32 s62, s62, 4096
    s_cbranch_scc0 L_f_h1
    s_branch L_f_h1ok
L_F7:
    s_cmp_eq_u32 s31, 7
    s_cbranch_scc0 L_F8
    s_load_dword s30, s[28:29], 0
    v_mov_b32 v4, 1
    s_waitcnt lgkmcnt(0)
    s_mov_b64 exec, 1
    ds_add_u32 v2, v4 offset:580
    s_mov_b64 exec, -1
    s_mov_b32 s44, s28
    s_mov_b32 s45, s29
    s_mov_b32 s46, 1441792
    s_mov_b32 s47, 0x20000
    s_cmp_lt_u32 s32, 4
    s_cselect_b32 s50, 6, 8
    s_cselect_b32 s51, 0, 8
    s_cmp_lt_u32 s33, s50
    s_cbranch_scc0 L_fin3
    s_mul_i32 s49, s32, 3072
    s_add_u32 s49, s49, 49152
    v_lshlrev_b32 v102, 7, v0
    v_mov_b32 v104, 0
    s_mov_b32 s62, 0
L_7_q:
    s_sleep 4
    ds_read_b32 v105, v104 offset:592
    s_waitcnt lgkmcnt(0)
    v_cmp_gt_u32 vcc, 1, v105
    s_cbranch_vccz L_7_qok
    s_add_u32 s62, s62, 4096
    s_cbranch_scc0 L_7_q
L_7_qok:
    s_add_u32 s30, s30, 1
    s_and_b32 s34, s30, 0x7f
    s_xor_b32 s35, s34, 0x5a
    s_lshl_b32 s3, s35, 8
    s_or_b32 s3, s3, s34
    s_mul_i32 s54, s50, s32
    s_add_u32 s54, s54, s33
    s_and_b32 s54, s54, 6
    s_cmp_eq_u32 s54, 6
    s_cselect_b32 s54, 4, 16
    s_mov_b64 exec, 0xffffff
    s_mov_b32 s62, 0
L_f_h:
    s_sleep 2
    buffer_load_dword v103, v102, s[44:47], s49 offen sc1
    s_add_u32 s62, s62, 67108864
    s_waitcnt vmcnt(0)
    s_cbranch_scc1 L_f_hok
    v_cmp_eq_u32 vcc, s3, v103
    s_nop 0
    s_bcnt1_i32_b64 s53, vcc
    s_cmp_lt_u32 s53, s54
    s_cbranch_scc1 L_f_h
L_f_hok:
    s_mov_b64 exec, -1
    v_mov_b32 v103, 1
    ds_write_b32 v2, v103 offset:584
    s_mul_i32 s50, s50, s32
    s_add_u32 s50, s50, s33
    s_sub_u32 s50, s50, s51
    v_mov_b32 v9, v3
    v_lshrrev_b32 v4, 4, v0
    v_lshlrev_b32 v81, 14, v4
    v_bfe_u32 v6, v0, 2, 2
    v_lshl_add_u32 v81, v6, 11, v81
    v_and_b32 v6, 3, v0
    v_lshl_add_u32 v81, v6, 4, v81
    s_bfe_u32 s52, s50, 0x20001
    s_lshl_b32 s52, s52, 2
    s_lshl_b32 s20, 0x000f000f, s52
    s_mov_b32 s21, s20
    s_lshr_b32 s52, s50, 3
    s_lshl_b32 s53, s52, 8
    v_add_u32 v3, s53, v3
    s_lshl_b32 s52, s52, 7
    v_and_b32 v6, 7, v0
    v_lshlrev_b32 v6, 4, v6
    v_and_b32 v7, 8, v0
    v_lshl_add_u32 v7, v4, 1, v7
    v_add3_u32 v101, v6, v7, s52
    s_mov_b32 s36, s24
    s_mov_b32 s37, s25
    s_mov_b32 s38, 896
    s_mov_b32 s39, 0x20000
    v_bfe_u32 v5, v0, 0, 1
    v_mul_u32_u24 v5, 0x5a, v5
    v_xor_b32 v5, s34, v5
    v_mov_b32 v48, v5
    v_mov_b32 v49, 0
    v_mov_b32 v50, 0
    v_mov_b32 v51, 0
    v_mov_b32 v102, 0
    s_mov_b32 s62, 0
L_7_g:
    s_sleep 4
    ds_read_b32 v103, v102 offset:576
    s_waitcnt lgkmcnt(0)
    v_cmp_gt_u32 vcc, 2, v103
    s_cbranch_vccz L_7_gok
    s_add_u32 s62, s62, 4096
    s_cbranch_scc0 L_7_g
L_7_gok:
    v_mov_b32 v102, 0
    ds_read_b32 v102, v102 offset:588
    s_waitcnt lgkmcnt(0)
    v_readfirstlane_b32 s48, v102
    s_lshl_b32 s40, s50, 5
    s_add_u32 s40, s40, s48
    s_add_u32 s40, s40, 262144
    s_add_u32 s41, s40, 65536
    s_add_u32 s42, s40, 131072
    s_add_u32 s43, s40, 196608
    s_bitcmp1_b32 s50, 0
    s_cbranch_scc1 L_7_o
    buffer_load_dwordx4 v[36:39], v81, s[44:47], s40 offen sc1
    buffer_load_dwordx4 v[40:43], v81, s[44:47], s41 offen sc1
    buffer_load_dwordx4 v[44:47], v81, s[44:47], s42 offen sc1
    s_mov_b32 exec_hi, 0
    buffer_load_dwordx4 v[48:51], v81, s[44:47], s43 offen sc1
    buffer_load_ushort v125, v101, s[36:39], 0 offen
    s_mov_b32 exec_hi, -1
L_7_o:
    v_mov_b32 v102, 0
    s_mov_b32 s62, 0
L_7_a:
    s_sleep 1
    ds_read_b32 v103, v102 offset:576
    s_waitcnt lgkmcnt(0)
    v_cmp_gt_u32 vcc, 7, v103
    s_cbranch_vccz L_7_aok
    s_add_u32 s62, s62, 4096
    s_cbranch_scc0 L_7_a
L_7_aok:
    ds_read2st64_b32 v[16:17], v9 offset0:64 offset1:65
    ds_read2st64_b32 v[18:19], v9 offset0:66 offset1:67
    ds_read2st64_b32 v[20:21], v9 offset0:68 offset1:69
    ds_read_b32 v22, v9 offset:17920
    v_mov_b32 v23, 0
    s_waitcnt lgkmcnt(0)
    v_pk_add_f32 v[16:17], v[16:17], v[18:19]
    v_pk_add_f32 v[20:21], v[20:21], v[22:23]
    v_pk_add_f32 v[16:17], v[16:17], v[20:21]
    v_add_f32 v16, v16, v17
    v_mov_b32 v17, v16
    v_and_b32 v14, 31, v0
    v_lshlrev_b32 v15, 1, v14
    v_permlane32_swap_b32 v16, v17
    v_lshlrev_b32 v14, 2, v14
    v_add_u32 v14, 6144, v14
    v_mov_b32 v1, 8192
    v_mov_b32 v31, 0
    s_mov_b32 s59, 0x43e00000
    s_setprio 3
    s_mov_b32 s62, 0
    s_barrier
L_7_t:
    ds_read_b32 v70, v31 offset:600
    ds_read_b128 v[56:59], v1
    ds_read_b128 v[60:63], v1 offset:16
    ds_read_b128 v[64:67], v1 offset:32
    ds_read_b64 v[68:69], v1 offset:48
    ds_read2_b32 v[24:25], v14 offset0:0 offset1:32
    ds_read2_b32 v[26:27], v14 offset0:64 offset1:96
    ds_read2_b32 v[28:29], v14 offset0:128 offset1:160
    ds_read_b32 v30, v14 offset:768
    s_waitcnt lgkmcnt(6)
    v_cmp_ne_u32 vcc, 7, v70
    v_pk_add_f32 v[56:57], v[56:57], v[58:59]
    v_pk_add_f32 v[60:61], v[60:61], v[62:63]
    s_waitcnt lgkmcnt(4)
    v_pk_add_f32 v[64:65], v[64:65], v[66:67]
    v_pk_add_f32 v[56:57], v[56:57], v[60:61]
    v_pk_add_f32 v[64:65], v[64:65], v[68:69]
    v_pk_add_f32 v[56:57], v[56:57], v[64:65]
    v_mul_f32 v60, v56, v56
    v_fma_f32 v61, v56, v56, -v60
    v_fma_f32 v60, v57, s59, -v60
    v_sub_f32 v60, v60, v61
    v_mul_f32 v60, 0x36a72f05, v60
    v_max_f32 v60, 0, v60
    v_cvt_pk_bf16_f32 v60, 0, v60
    v_add_f32 v60, 0x3727c5ac, v60
    v_cvt_pk_bf16_f32 v60, 0, v60
    v_sqrt_f32 v60, v60
    v_mul_f32 v62, 0x3b124925, v56
    v_cvt_pk_bf16_f32 v60, 0, v60
    s_waitcnt lgkmcnt(0)
    v_rcp_f32 v60, v60
    v_pk_add_f32 v[24:25], v[24:25], v[26:27]
    v_pk_add_f32 v[28:29], v[28:29], v[30:31]
    v_cvt_pk_bf16_f32 v62, 0, v62
    v_pk_add_f32 v[24:25], v[24:25], v[28:29]
    v_fma_f32 v24, -v62, v16, v24
    v_add_f32 v24, v24, v25
    v_fma_f32 v24, v24, v60, v17
    v_cvt_pk_bf16_f32 v24, 0, v24
    v_mul_f32 v25, 0xbfb8aa3b, v24
    v_exp_f32 v25, v25
    s_nop 0
    v_add_f32 v25, 1.0, v25
    v_rcp_f32 v25, v25
    s_nop 0
    v_mul_f32 v25, v24, v25
    v_cvt_pk_bf16_f32 v24, 0, v25
    s_cbranch_vccnz L_7_tr
L_7_tok:
    ds_write_b16_d16_hi v15, v24 offset:8448
    ds_write_b32 v31, v1 offset:604
    s_barrier
    s_bitcmp1_b32 s50, 0
    s_cbranch_scc1 L_fin3
    ds_read_b32 v96, v3 offset:12288
    ds_read_b32 v100, v3 offset:14336
    s_cmp_eq_u32 s50, 0
    s_cbranch_scc0 L_7_e
    s_mov_b64 exec, 1
    v_mov_b32 v6, s30
    buffer_store_dword v6, v2, s[44:47], 0 offen
    s_mov_b64 exec, -1
L_7_e:
    s_barrier
    s_waitcnt lgkmcnt(0)
    s_sleep 9
    s_mov_b32 s62, 0
    s_branch L_x5_w
.p2align 6
    s_nop 0
    s_nop 0
    s_nop 0
    s_nop 0
    s_nop 0
L_x5:
    s_wqm_b64 exec, s[4:5]
    s_cbranch_scc0 L_x5_z0
    buffer_load_dwordx4 v[36:39], v81, s[44:47], s40 offen sc1
L_x5_z0:
    s_wqm_b64 exec, s[6:7]
    s_cbranch_scc0 L_x5_z1
    buffer_load_dwordx4 v[40:43], v81, s[44:47], s41 offen sc1
L_x5_z1:
    s_wqm_b64 exec, s[8:9]
    s_cbranch_scc0 L_x5_z2
    buffer_load_dwordx4 v[44:47], v81, s[44:47], s42 offen sc1
L_x5_z2:
    s_wqm_b64 exec, s[10:11]
    s_cbranch_scc0 L_x5_z3
    buffer_load_dwordx4 v[48:51], v81, s[44:47], s43 offen sc1
L_x5_z3:
    s_mov_b64 exec, -1
    s_add_u32 s62, s62, 4096
    s_cbranch_scc1 L_x5_r
L_x5_w:
    s_waitcnt vmcnt(0)
    v_cmp_ne_u32_sdwa s[4:5], v36, v5 src0_sel:BYTE_0 src1_sel:DWORD
    v_cmp_ne_u32_sdwa s[6:7], v40, v5 src0_sel:BYTE_0 src1_sel:DWORD
    v_cmp_ne_u32_sdwa s[8:9], v44, v5 src0_sel:BYTE_0 src1_sel:DWORD
    v_cmp_ne_u32_sdwa s[10:11], v48, v5 src0_sel:BYTE_0 src1_sel:DWORD
    v_pk_add_f32 v[34:35], v[38:39], v[42:43]
    v_pk_add_f32 v[32:33], v[46:47], v[50:51]
    v_pk_add_f32 v[34:35], v[34:35], v[32:33]
    s_or_b64 vcc, s[4:5], s[6:7]
    s_or_b64 vcc, vcc, s[8:9]
    s_or_b64 vcc, vcc, s[10:11]
    s_cbranch_scc1 L_x5
L_x5_ok:
    v_xor_b32 v36, v36, v5
    v_xor_b32 v40, v40, v5
    v_xor_b32 v44, v44, v5
    v_xor_b32 v48, v48, v5
    v_pk_add_f32 v[36:37], v[36:37], v[40:41]
    v_pk_add_f32 v[44:45], v[44:45], v[48:49]
    v_pk_add_f32 v[32:33], v[36:37], v[44:45]
    s_nop 1
    v_permlane32_swap_b32 v32, v34
    v_permlane32_swap_b32 v33, v35
    v_pk_add_f32 v[32:33], v[32:33], v[34:35]
    s_nop 1
    v_permlane16_swap_b32 v32, v33
    v_add_f32 v32, v32, v33
    s_nop 1
    v_add_f32_dpp v32, v32, v32 row_ror:8 row_mask:0xf bank_mask:0xf
    s_nop 1
    v_add_f32_dpp v32, v32, v32 row_ror:4 row_mask:0xf bank_mask:0xf
    v_cvt_pk_bf16_f32 v32, 0, v32
    v_mul_f32 v32, v100, v32
    v_cvt_pk_bf16_f32 v32, 0, v32
    v_add_f32 v32, v96, v32
    s_mov_b64 exec, s[20:21]
    v_cvt_pk_bf16_f32 v32, 0, v32
    buffer_store_short_d16_hi v32, v101, s[36:39], 0 offen
L_fin3:
    s_endpgm
L_7_tr:
    s_add_u32 s62, s62, 4096
    s_cbranch_scc0 L_7_t
    s_branch L_7_tok
L_x5_r:
    s_waitcnt vmcnt(0)
    s_mov_b64 vcc, 0
    s_branch L_x5_ok
L_F8:
    s_lshl_b32 s48, s2, 7
    s_add_u32 s48, s48, 524288
    s_add_u32 s49, s48, 8192
    s_mov_b32 s52, -1
    s_mov_b32 s53, -1
    s_mov_b32 s54, 0
    s_waitcnt lgkmcnt(0)
    s_load_dword s10, s[28:29], s48 glc
    s_load_dword s11, s[28:29], s49 glc
    s_waitcnt lgkmcnt(0)
L_8_l:
    s_memtime s[4:5]
    s_waitcnt lgkmcnt(0)
    s_load_dword s10, s[28:29], s48 glc
    s_waitcnt lgkmcnt(0)
    s_memtime s[6:7]
    s_lshr_b32 s8, s33, 0
    s_add_u32 s8, s8, s54
    s_bitcmp1_b32 s8, 0
    s_waitcnt lgkmcnt(0)
    s_cbranch_scc0 L_8_n0
    s_sleep 3
L_8_n0:
    s_sub_u32 s4, s6, s4
    s_min_u32 s52, s52, s4
    s_memtime s[4:5]
    s_waitcnt lgkmcnt(0)
    s_load_dword s10, s[28:29], s49 glc
    s_waitcnt lgkmcnt(0)
    s_memtime s[6:7]
    s_lshr_b32 s8, s33, 1
    s_add_u32 s8, s8, s54
    s_bitcmp1_b32 s8, 0
    s_waitcnt lgkmcnt(0)
    s_cbranch_scc0 L_8_n1
    s_sleep 3
L_8_n1:
    s_sub_u32 s4, s6, s4
    s_min_u32 s53, s53, s4
    s_cmp_lt_u32 s53, s52
    s_cselect_b32 s55, 8192, 0
    v_mov_b32 v3, s55
    ds_write_b32 v2, v3 offset:588
    s_add_u32 s54, s54, 1
    s_cmp_lt_u32 s54, 5
    s_cbranch_scc1 L_8_l
    s_endpgm
L_pf:
    s_cmp_lt_u32 s31, 10
    s_cbranch_scc1 L_end
    s_mul_i32 s50, s33, 6
    s_add_u32 s50, s50, s31
    s_sub_u32 s50, s50, 94
    s_cmp_lt_u32 s50, 56
    s_cbranch_scc0 L_end
    s_cmp_lt_u32 s32, 4
    s_cselect_b32 s52, 6, 8
    s_cselect_b32 s53, 0, 8
    s_cselect_b32 s56, 0x77777777, -1
    s_cselect_b32 s58, 21, 28
    s_mul_i32 s52, s52, s32
    s_sub_u32 s52, s52, s53
    s_lshr_b32 s51, s50, 1
    s_waitcnt lgkmcnt(0)
    s_bitcmp1_b32 s50, 0
    s_cbranch_scc1 L_pf_2
    s_mul_i32 s54, s51, 57344
    s_lshl_b32 s52, s52, 6
    s_add_u32 s54, s54, s52
    v_lshrrev_b32 v4, 2, v0
    v_mul_u32_u24 v4, 3584, v4
    v_and_b32 v5, 3, v0
    v_lshl_add_u32 v4, v5, 7, v4
    v_add_u32 v4, s54, v4
    s_branch L_pf_3
L_pf_2:
    s_mul_i32 s52, s52, 28672
    s_lshl_b32 s54, s51, 13
    s_add_u32 s54, s54, s52
    v_lshl_add_u32 v4, v0, 7, s54
    s_mov_b64 s[16:17], s[18:19]
    s_cmp_lt_u32 s51, s58
    s_cselect_b32 s56, -1, 0
L_pf_3:
    s_mov_b32 s57, s56
    s_barrier
    s_barrier
    s_mov_b64 exec, s[56:57]
    s_cbranch_execz L_end
    global_load_dword v6, v4, s[16:17]
    s_endpgm
L_end:
    s_endpgm
L_code_end:
.section .rodata,"a"
.p2align 6
.amdhsa_kernel adaLN_cond__sliding_block_cached__dense_activation_silu__decode_kernel
  .amdhsa_next_free_vgpr 128
  .amdhsa_next_free_sgpr 96
  .amdhsa_accum_offset 128
  .amdhsa_group_segment_fixed_size 0
  .amdhsa_kernarg_size 104
  .amdhsa_user_sgpr_count 2
  .amdhsa_user_sgpr_kernarg_segment_ptr 1
  .amdhsa_system_sgpr_workgroup_id_x 1
.end_amdhsa_kernel
```
